```python
import torch

def _softmax(x, axis=-1):
    return torch.softmax(x, dim=axis)
def _gelu(x):
    return torch.nn.functional.gelu(x, approximate="tanh")
def _silu(x):
    return torch.nn.functional.silu(x)
def _sigmoid(x):
    return torch.sigmoid(x)
def _layernorm(x, axis=-1, eps=1e-5):
    m = x.mean(dim=axis, keepdim=True)
    v = x.var(dim=axis, keepdim=True, unbiased=False)
    return (x - m) / torch.sqrt(v + eps)
def _scatter_add(tgt, idx, src, axis=0):
    return tgt.clone().index_add_(axis, idx, src)
def _segment_sum(src, seg, n):
    out = torch.zeros((n,) + src.shape[1:], dtype=src.dtype)
    return out.index_add_(0, seg, src)
def _pad(x, pw):
    flat = tuple(v for pair in reversed(pw) for v in pair)
    return torch.nn.functional.pad(x, flat)

kernel_name = 'parallel_sum__mha_block__mixer_s_mlp__prompt'

def setup_inputs():

    _w = (lambda a: (lambda t: t.to(torch.bfloat16) if t.is_floating_point() else t)(torch.as_tensor(a)))
    def _A_setup():
        B, S, D, H = 1, 2048, 512, 32
        return {
            "x": _w((lambda *s: torch.randn(*s, dtype=torch.bfloat16) * 0.05)(B, S, D)),
            "wqkv": _w((lambda *s: torch.randn(*s, dtype=torch.bfloat16) * 0.1)(D, 3 * D)),
            "wo": _w((lambda *s: torch.randn(*s, dtype=torch.bfloat16) * 0.05)(D, D)),
        }
    _A_in = _A_setup()

    def _B_setup():
        B, S, D, F = 1, 2048, 512, 1376
        return {
            "x":  _w((lambda *s: torch.randn(*s, dtype=torch.bfloat16) * 0.05)(B, S, D)),
            "w1": _w((lambda *s: torch.randn(*s, dtype=torch.bfloat16) * 3.2)(D, D) * (D ** -0.5)),
            "w2": _w((lambda *s: torch.randn(*s, dtype=torch.bfloat16) * 3.2)(D, D) * (D ** -0.5)),
            "w3": _w((lambda *s: torch.randn(*s, dtype=torch.bfloat16) * 3.2)(D, F) * (D ** -0.5)),
            "w4": _w((lambda *s: torch.randn(*s, dtype=torch.bfloat16) * 3.2)(F, D) * (F ** -0.5)),
        }
    _B_in = _B_setup()

    return {
        "A_x": _A_in["x"],
        "A_wqkv": _A_in["wqkv"],
        "A_wo": _A_in["wo"],
        "B_x": _B_in["x"],
        "B_w1": _B_in["w1"],
        "B_w2": _B_in["w2"],
        "B_w3": _B_in["w3"],
        "B_w4": _B_in["w4"],
    }

def reference(A_x, A_wqkv, A_wo, B_x, B_w1, B_w2, B_w3, B_w4):
    def _A_ref(x, wqkv, wo):
        B, S, D = x.shape
        H = 32
        Dh = D // H
        qkv = (lambda x, *d: x.permute(*d))((x @ wqkv).reshape(B, S, 3, H, Dh), 2, 0, 3, 1, 4)
        q, k, v = qkv[0], qkv[1], qkv[2]
        scores = torch.einsum("bhqd,bhkd->bhqk", q, k) * (Dh ** -0.5)
        p = _softmax(scores, axis=-1)
        o = torch.einsum("bhqk,bhkd->bhqd", p, v)
        return (lambda x, *d: x.permute(*d))(o, 0, 2, 1, 3).reshape(B, S, D) @ wo

    def _B_ref(x, w1, w2, w3, w4):
        B, S, D = x.shape
        h = _gelu(_layernorm(x, axis=-1) @ w1)
        c = D // 4
        g0 = _pad(h[:, :, 0*c:1*c], ((0, 0), (1, 0), (0, 0)))[:, :S, :]
        g1 = _pad(h[:, :, 1*c:2*c], ((0, 0), (0, 1), (0, 0)))[:, 1:, :]
        g2 = _pad(h[:, :, 2*c:3*c], ((0, 0), (2, 0), (0, 0)))[:, :S, :]
        g3 = _pad(h[:, :, 3*c:   ], ((0, 0), (0, 2), (0, 0)))[:, 2:, :]
        hs = torch.concatenate([g0, g1, g2, g3], axis=-1) @ w2
        x1 = x + hs
        h2 = _gelu(_layernorm(x1, axis=-1) @ w3) @ w4
        return x1 + h2

    x = A_x
    xn = _layernorm(x, axis=-1)
    return x + _A_ref(xn, A_wqkv, A_wo) + _B_ref(xn, B_w1, B_w2, B_w3, B_w4)
```

```asm
; @launch grid=(256,1,1) block=(512,1,1) lds=163840
.amdgcn_target "amdgcn-amd-amdhsa--gfx950"
.text
.globl parallel_sum__mha_block__mixer_s_mlp__prompt_kernel
.p2align 8
.type parallel_sum__mha_block__mixer_s_mlp__prompt_kernel,@function
parallel_sum__mha_block__mixer_s_mlp__prompt_kernel:
    s_cmp_ge_u32 s2, 256
    s_cbranch_scc1 K1_END
    s_load_dwordx4 s[20:23], s[0:1], 0
    s_load_dwordx2 s[24:25], s[0:1], 32
    s_load_dwordx2 s[26:27], s[0:1], 80
    s_load_dwordx2 s[6:7], s[0:1], 16
    s_load_dwordx2 s[52:53], s[0:1], 40
    s_load_dwordx4 s[56:59], s[0:1], 48
    s_load_dwordx2 s[98:99], s[0:1], 72
    s_getpc_b64 s[92:93]
    s_and_b32 s40, s2, 0xf8
    v_lshrrev_b32 v2, 6, v0
    v_add_u32 v2, s40, v2
    v_lshlrev_b32 v2, 1, v2
    v_and_b32 v3, 1, v0
    v_add_u32 v2, v2, v3
    v_lshlrev_b32 v2, 7, v2
    v_min_u32 v2, K1_END-parallel_sum__mha_block__mixer_s_mlp__prompt_kernel-256, v2
    s_mov_b64 exec, 3
    global_load_dword v212, v2, s[92:93]
    s_mov_b64 exec, -1
    v_lshrrev_b32 v2, 6, v0
    v_and_b32 v1, 63, v0
    v_readfirstlane_b32 s28, v2
    s_and_b32 s40, s2, 3
    s_lshl_b32 s31, s40, 2
    s_bfe_u32 s40, s2, 0x20003
    s_add_u32 s31, s31, s40
    s_lshl_b32 s42, s40, 1
    s_bfe_u32 s40, s2, 0x10002
    s_lshl_b32 s32, s40, 3
    s_lshr_b32 s41, s2, 5
    s_add_u32 s32, s32, s41
    s_add_u32 s42, s42, s41
    s_and_b32 s42, s42, 7
    s_and_b32 s29, s28, 3
    s_lshr_b32 s30, s28, 2
    s_mul_i32 s40, s30, 24
    s_add_u32 s33, s40, s32
    s_lshl_b32 s40, s32, 1
    s_add_u32 s40, s40, s30
    s_sub_u32 s40, s40, 8
    s_cmp_lt_u32 s32, 8
    s_cselect_b32 s33, s33, s40
    s_lshr_b32 s34, s33, 3
    s_lshl_b32 s36, s33, 7
    s_sub_u32 s40, s36, 3072
    s_cmp_eq_u32 s34, 3
    s_cselect_b32 s36, s40, s36
    s_mov_b32 s35, 3072
    s_cmov_b32 s35, 1024
    s_lshl_b32 s46, s35, 3
    s_lshl_b32 s47, s35, 6
    v_lshrrev_b32 v2, 3, v1
    v_lshrrev_b32 v3, 4, v1
    v_and_b32 v4, 7, v1
    v_xor_b32 v5, v4, v3
    v_lshlrev_b32 v5, 4, v5
    s_lshl_b32 s40, s28, 4
    v_add_u32 v6, s40, v2
    v_lshl_add_u32 v6, v6, 10, v5
    v_xor_b32 v7, 64, v6
    v_add_u32 v7, 0x2000, v7
    v_and_b32 v3, 1, v3
    v_lshlrev_b32 v3, 2, v3
    v_xor_b32 v3, v3, v4
    v_lshlrev_b32 v3, 4, v3
    s_lshl_b32 s40, s29, 4
    v_add_u32 v5, s40, v2
    v_mul_lo_u32 v8, v5, s35
    v_add3_u32 v8, v8, v3, s36
    s_lshl_b32 s62, s31, 17
    s_lshl_b32 s39, s28, 11
    s_waitcnt lgkmcnt(0)
    s_mov_b32 s8, s20
    s_mov_b32 s9, s21
    s_mov_b32 s10, 0x200000
    s_mov_b32 s11, 0x20000
    s_cmp_eq_u32 s34, 3
    s_cselect_b32 s12, s24, s22
    s_cselect_b32 s13, s25, s23
    s_lshl_b32 s14, s35, 9
    s_mov_b32 s15, 0x20000
    s_mov_b32 s16, s26
    s_mov_b32 s17, s27
    s_mov_b32 s18, 0x1c00000
    s_mov_b32 s19, 0x20000
    s_cmp_ge_u32 s2, 8
    s_cbranch_scc1 K1_NOINIT
    s_cmp_lg_u32 s28, 7
    s_cbranch_scc1 K1_NOINIT
    v_mov_b32 v172, 0
    v_lshlrev_b32 v186, 8, v1
    s_lshl_b32 s40, s2, 14
    s_add_u32 s40, s40, 0x1b00000
    buffer_store_dword v172, v186, s[16:19], s40 offen sc1
K1_NOINIT:
    s_lshl_b32 s55, s31, 4
    s_add_u32 s55, s55, s32
    s_lshl_b32 s55, s55, 3
    s_add_u32 s55, s55, s28
    s_lshl_b32 s40, s55, 10
    v_lshlrev_b32 v186, 4, v1
    buffer_load_dwordx4 v[196:199], v186, s[8:11], s40 offen
    s_lshl_b32 s37, s42, 7
    s_add_u32 m0, s39, 0
    s_add_u32 s37, s37, s62
    buffer_load_dwordx4 v6, s[8:11], s37 offen lds
    s_add_u32 m0, s39, 16384
    s_mul_i32 s38, s42, s47
    buffer_load_dwordx4 v8, s[12:15], s38 offen lds
    s_add_u32 m0, s39, 1024
    s_add_u32 s42, s42, 1
    buffer_load_dwordx4 v7, s[8:11], s37 offen lds
    s_add_u32 m0, s39, 17408
    s_add_u32 s38, s38, s46
    buffer_load_dwordx4 v8, s[12:15], s38 offen lds
    s_and_b32 s42, s42, 7
    s_mov_b32 s92, s98
    s_mov_b32 s93, s99
    s_mov_b32 s94, 0x100
    s_mov_b32 s95, 0x20000
    s_lshr_b32 s40, s2, 3
    s_lshl_b32 s40, s40, 2
    s_and_b32 s41, s2, 3
    s_add_u32 s40, s40, s41
    s_add_u32 s101, s40, 128
    s_cmp_lt_u32 s40, 88
    s_cselect_b32 s101, s40, s101
    s_add_u32 s40, s40, 88
    s_cmp_ge_u32 s32, 8
    s_cselect_b32 s101, s40, s101
    s_mul_i32 s60, s101, 2979
    s_lshr_b32 s60, s60, 16
    s_mul_i32 s40, s60, 22
    s_sub_u32 s61, s101, s40
    s_mov_b64 s[48:49], s[56:57]
    s_mov_b32 s50, 1409024
    s_mov_b32 s51, 0x20000
    s_mov_b32 s4, 2752
    s_mov_b32 s3, 0x1800000
    s_mov_b32 s54, 72
    s_mov_b32 s41, 44
    s_mov_b32 s5, 0
    s_cmp_lt_u32 s101, 88
    s_cbranch_scc1 K1_JOB
    s_and_b32 s61, s101, 7
    s_mov_b32 s4, 1024
    s_mov_b32 s41, 16
    s_mov_b32 s50, 0x80000
    s_sub_u32 s60, s101, 88
    s_mov_b64 s[48:49], s[52:53]
    s_mov_b32 s3, 0x1700000
    s_mov_b32 s54, 96
    s_cmp_lt_u32 s101, 120
    s_cbranch_scc1 K1_JOBS
    s_sub_u32 s60, s101, 120
    s_mov_b64 s[48:49], s[6:7]
    s_mov_b32 s3, 0x1780000
    s_mov_b32 s54, 104
    s_mov_b32 s5, 1
    s_cmp_lt_u32 s101, 152
    s_cbranch_scc1 K1_JOBS
    s_sub_u32 s60, s101, 152
    s_mov_b64 s[48:49], s[58:59]
    s_mov_b32 s50, 1409024
    s_mov_b32 s3, 0x1980000
    s_mov_b32 s54, 112
    s_mov_b32 s5, 0
    s_cmp_lt_u32 s101, 240
    s_cbranch_scc1 K1_JOBS
    s_mov_b32 s3, 0x40000000
K1_JOBS:
    s_lshr_b32 s60, s60, 3
K1_JOB:
    s_lshl_b32 s40, s60, 3
    s_add_u32 s40, s40, s28
    s_mul_i32 s41, s41, s40
    s_lshl_b32 s63, s61, 1
    s_add_u32 s41, s41, s63
    s_lshl_b32 s41, s41, 10
    s_add_u32 s3, s3, s41
    s_mul_i32 s40, s40, s4
    s_lshl_b32 s40, s40, 4
    s_lshl_b32 s63, s61, 7
    s_add_u32 s63, s63, s40
    v_mul_lo_u32 v11, v2, s4
    v_add_u32 v11, v11, v3
    s_lshl_b32 s4, s4, 3
    s_add_u32 s4, s4, s63
    v_mov_b32 v172, 0
    v_mov_b32 v173, 0
    v_mov_b32 v186, 0x27f00
    ds_write_b64 v186, v[172:173]
    ds_write_b32 v186, v172 offset:8
    s_waitcnt lgkmcnt(0)
    s_barrier
    s_lshl_b32 s37, s42, 7
    s_add_u32 m0, s39, 32768
    s_add_u32 s37, s37, s62
    buffer_load_dwordx4 v6, s[8:11], s37 offen lds
    s_add_u32 m0, s39, 49152
    s_mul_i32 s38, s42, s47
    buffer_load_dwordx4 v8, s[12:15], s38 offen lds
    s_add_u32 m0, s39, 33792
    s_add_u32 s42, s42, 1
    buffer_load_dwordx4 v7, s[8:11], s37 offen lds
    s_add_u32 m0, s39, 50176
    s_add_u32 s38, s38, s46
    buffer_load_dwordx4 v8, s[12:15], s38 offen lds
    s_and_b32 s42, s42, 7
    v_and_b32 v9, 31, v1
    v_lshrrev_b32 v10, 5, v1
    s_lshl_b32 s40, s29, 5
    v_add_u32 v2, s40, v9
    v_lshlrev_b32 v2, 7, v2
    v_bfe_u32 v3, v9, 1, 3
    v_xor_b32 v3, v3, v10
    v_bfe_u32 v4, v1, 2, 2
    v_lshlrev_b32 v5, 7, v4
    v_lshrrev_b32 v4, 1, v4
    v_lshl_add_u32 v5, v4, 6, v5
    v_bfe_u32 v4, v1, 4, 1
    v_lshl_add_u32 v5, v4, 5, v5
    v_and_b32 v187, 15, v1
    v_cmp_eq_u32 vcc, v187, v4
    v_and_b32 v4, 3, v1
    v_lshl_add_u32 v5, v4, 3, v5
    v_lshl_add_u32 v187, v10, 10, v5
    v_mov_b32 v4, 0x3f803f80
    v_cndmask_b32 v32, 0, v4, vcc
    s_add_u32 s40, s5, 9
    v_lshlrev_b32 v12, s40, v10
    s_lshl_b32 s40, s28, 11
    s_add_u32 s40, s40, 0x20000
    v_add3_u32 v12, v12, v5, s40
    s_lshl_b32 s40, s30, 13
    s_add_u32 s40, s40, 16384
    v_add_u32 v24, s40, v187
    v_xor_b32 v25, 64, v24
    s_and_b32 s40, s29, 1
    s_lshl_b32 s40, s40, 13
    s_add_u32 s40, s40, 16384
    s_lshr_b32 s41, s29, 1
    s_lshl_b32 s41, s41, 6
    v_xor_b32 v26, s41, v187
    v_add_u32 v26, s40, v26
    v_mov_b32 v33, v32
    v_mov_b32 v34, v32
    v_mov_b32 v35, v32
    v_mov_b32 v116, 0
    v_mov_b32 v117, 0
    v_mov_b32 v118, 0
    v_mov_b32 v119, 0
    v_mov_b32 v194, 0x3f803f80
    v_xor_b32 v4, 0, v3
    v_lshl_add_u32 v16, v4, 4, v2
    v_xor_b32 v4, 2, v3
    v_lshl_add_u32 v17, v4, 4, v2
    v_xor_b32 v4, 4, v3
    v_lshl_add_u32 v18, v4, 4, v2
    v_xor_b32 v4, 6, v3
    v_lshl_add_u32 v19, v4, 4, v2
    v_add_u32 v20, 65536, v16
    v_add_u32 v21, 65536, v17
    v_add_u32 v22, 65536, v18
    v_add_u32 v23, 65536, v19
    v_add_u32 v27, 65536, v24
    v_add_u32 v28, 65536, v25
    v_add_u32 v29, 65536, v26
    s_waitcnt vmcnt(8)
    s_xor_b32 s40, s28, 7
    s_lshr_b32 s41, s2, 3
    s_or_b32 s40, s40, s41
    s_cbranch_scc1 K1_NOFLAG
    v_mov_b32 v173, 1
    s_mov_b64 exec, 1
    buffer_atomic_add v173, v172, s[92:95], 0 offen sc1
    s_mov_b64 exec, -1
K1_NOFLAG:
    v_dot2_f32_bf16 v116, v196, v194, v116
    v_dot2_f32_bf16 v117, v196, v196, v117
    v_dot2_f32_bf16 v116, v197, v194, v116
    v_dot2_f32_bf16 v117, v197, v197, v117
    v_dot2_f32_bf16 v116, v198, v194, v116
    v_dot2_f32_bf16 v117, v198, v198, v117
    v_dot2_f32_bf16 v116, v199, v194, v116
    v_dot2_f32_bf16 v117, v199, v199, v117
    s_nop 1
    v_add_f32_dpp v116, v116, v116 row_shr:1 row_mask:0xf bank_mask:0xf bound_ctrl:0
    v_add_f32_dpp v117, v117, v117 row_shr:1 row_mask:0xf bank_mask:0xf bound_ctrl:0
    s_nop 0
    v_add_f32_dpp v116, v116, v116 row_shr:2 row_mask:0xf bank_mask:0xf bound_ctrl:0
    v_add_f32_dpp v117, v117, v117 row_shr:2 row_mask:0xf bank_mask:0xf bound_ctrl:0
    s_nop 0
    v_add_f32_dpp v116, v116, v116 row_shr:4 row_mask:0xf bank_mask:0xf bound_ctrl:0
    v_add_f32_dpp v117, v117, v117 row_shr:4 row_mask:0xf bank_mask:0xf bound_ctrl:0
    s_nop 0
    v_add_f32_dpp v116, v116, v116 row_shr:8 row_mask:0xf bank_mask:0xf bound_ctrl:0
    v_add_f32_dpp v117, v117, v117 row_shr:8 row_mask:0xf bank_mask:0xf bound_ctrl:0
    s_nop 0
    v_add_f32_dpp v116, v116, v116 row_bcast:15 row_mask:0xa bank_mask:0xf
    v_add_f32_dpp v117, v117, v117 row_bcast:15 row_mask:0xa bank_mask:0xf
    s_nop 0
    v_add_f32_dpp v116, v116, v116 row_bcast:31 row_mask:0xc bank_mask:0xf
    v_add_f32_dpp v117, v117, v117 row_bcast:31 row_mask:0xc bank_mask:0xf
    v_mul_f32 v116, 0x3b000000, v116
    v_mul_f32 v117, 0x3b000000, v117
    v_fma_f32 v117, -v116, v116, v117
    v_max_f32 v117, 0, v117
    v_add_f32 v117, 0x3727c5ac, v117
    v_rsq_f32 v117, v117
    s_lshl_b32 s40, s55, 3
    s_add_u32 s40, s40, 0x1600000
    s_mov_b32 exec_lo, 0
    s_mov_b32 exec_hi, 0x80000000
    buffer_store_dwordx2 v[116:117], v172, s[16:19], s40 offen sc1
    s_mov_b64 exec, -1
    s_cmp_eq_u32 s30, 1
    s_cbranch_scc1 K1_B1
    s_waitcnt vmcnt(5)
    s_barrier
    ds_read_b128 v[36:39], v16 offset:0
    ds_read_b64_tr_b16 v[40:41], v24 offset:0
    ds_read_b64_tr_b16 v[42:43], v24 offset:512
    ds_read_b64_tr_b16 v[44:45], v25 offset:0
    ds_read_b64_tr_b16 v[46:47], v25 offset:512
    ds_read_b128 v[52:55], v17 offset:0
    ds_read_b64_tr_b16 v[56:57], v24 offset:2048
    ds_read_b64_tr_b16 v[58:59], v24 offset:2560
    ds_read_b64_tr_b16 v[60:61], v25 offset:2048
    ds_read_b64_tr_b16 v[62:63], v25 offset:2560
    ds_read_b128 v[68:71], v18 offset:0
    ds_read_b64_tr_b16 v[72:73], v24 offset:4096
    ds_read_b64_tr_b16 v[74:75], v24 offset:4608
    ds_read_b64_tr_b16 v[76:77], v25 offset:4096
    ds_read_b64_tr_b16 v[78:79], v25 offset:4608
    s_waitcnt lgkmcnt(10)
    v_mfma_f32_32x32x16_bf16 v[84:99], v[40:43], v[36:39], 0
    v_mfma_f32_32x32x16_bf16 v[100:115], v[44:47], v[36:39], 0
    s_lshl_b32 s37, s42, 7
    s_add_u32 m0, s39, 65536
    s_add_u32 s37, s37, s62
    buffer_load_dwordx4 v6, s[8:11], s37 offen lds
    s_add_u32 m0, s39, 81920
    s_mul_i32 s38, s42, s47
    buffer_load_dwordx4 v8, s[12:15], s38 offen lds
    ds_read_b128 v[36:39], v19 offset:0
    ds_read_b64_tr_b16 v[40:41], v24 offset:6144
    ds_read_b64_tr_b16 v[42:43], v24 offset:6656
    ds_read_b64_tr_b16 v[44:45], v25 offset:6144
    ds_read_b64_tr_b16 v[46:47], v25 offset:6656
    s_waitcnt lgkmcnt(10)
    v_mfma_f32_32x32x16_bf16 v[84:99], v[56:59], v[52:55], v[84:99]
    v_mfma_f32_32x32x16_bf16 v[100:115], v[60:63], v[52:55], v[100:115]
    s_add_u32 m0, s39, 66560
    s_add_u32 s42, s42, 1
    buffer_load_dwordx4 v7, s[8:11], s37 offen lds
    s_add_u32 m0, s39, 82944
    s_add_u32 s38, s38, s46
    buffer_load_dwordx4 v8, s[12:15], s38 offen lds
    s_and_b32 s42, s42, 7
    s_waitcnt vmcnt(5)
    s_barrier
    ds_read_b128 v[52:55], v16 offset:32768
    ds_read_b64_tr_b16 v[56:57], v24 offset:32768
    ds_read_b64_tr_b16 v[58:59], v24 offset:33280
    ds_read_b64_tr_b16 v[60:61], v25 offset:32768
    ds_read_b64_tr_b16 v[62:63], v25 offset:33280
    s_waitcnt lgkmcnt(10)
    v_mfma_f32_32x32x16_bf16 v[84:99], v[72:75], v[68:71], v[84:99]
    v_mfma_f32_32x32x16_bf16 v[100:115], v[76:79], v[68:71], v[100:115]
    s_lshl_b32 s37, s42, 7
    s_add_u32 m0, s39, 98304
    s_add_u32 s37, s37, s62
    buffer_load_dwordx4 v6, s[8:11], s37 offen lds
    ds_read_b128 v[68:71], v17 offset:32768
    ds_read_b64_tr_b16 v[72:73], v24 offset:34816
    ds_read_b64_tr_b16 v[74:75], v24 offset:35328
    ds_read_b64_tr_b16 v[76:77], v25 offset:34816
    ds_read_b64_tr_b16 v[78:79], v25 offset:35328
    s_waitcnt lgkmcnt(10)
    v_mfma_f32_32x32x16_bf16 v[84:99], v[40:43], v[36:39], v[84:99]
    v_mfma_f32_32x32x16_bf16 v[100:115], v[44:47], v[36:39], v[100:115]
    s_add_u32 m0, s39, 114688
    s_mul_i32 s38, s42, s47
    buffer_load_dwordx4 v8, s[12:15], s38 offen lds
    ds_read_b128 v[36:39], v18 offset:32768
    ds_read_b64_tr_b16 v[40:41], v24 offset:36864
    ds_read_b64_tr_b16 v[42:43], v24 offset:37376
    ds_read_b64_tr_b16 v[44:45], v25 offset:36864
    ds_read_b64_tr_b16 v[46:47], v25 offset:37376
    s_waitcnt lgkmcnt(10)
    v_mfma_f32_32x32x16_bf16 v[84:99], v[56:59], v[52:55], v[84:99]
    v_mfma_f32_32x32x16_bf16 v[100:115], v[60:63], v[52:55], v[100:115]
    s_add_u32 m0, s39, 99328
    s_add_u32 s42, s42, 1
    buffer_load_dwordx4 v7, s[8:11], s37 offen lds
    ds_read_b128 v[52:55], v19 offset:32768
    ds_read_b64_tr_b16 v[56:57], v24 offset:38912
    ds_read_b64_tr_b16 v[58:59], v24 offset:39424
    ds_read_b64_tr_b16 v[60:61], v25 offset:38912
    ds_read_b64_tr_b16 v[62:63], v25 offset:39424
    s_waitcnt lgkmcnt(10)
    v_mfma_f32_32x32x16_bf16 v[84:99], v[72:75], v[68:71], v[84:99]
    v_mfma_f32_32x32x16_bf16 v[100:115], v[76:79], v[68:71], v[100:115]
    s_add_u32 m0, s39, 115712
    s_add_u32 s38, s38, s46
    buffer_load_dwordx4 v8, s[12:15], s38 offen lds
    s_and_b32 s42, s42, 7
    s_waitcnt vmcnt(4)
    s_barrier
    ds_read_b128 v[68:71], v20 offset:0
    ds_read_b64_tr_b16 v[72:73], v27 offset:0
    ds_read_b64_tr_b16 v[74:75], v27 offset:512
    ds_read_b64_tr_b16 v[76:77], v28 offset:0
    ds_read_b64_tr_b16 v[78:79], v28 offset:512
    s_waitcnt lgkmcnt(10)
    v_mfma_f32_32x32x16_bf16 v[84:99], v[40:43], v[36:39], v[84:99]
    v_mfma_f32_32x32x16_bf16 v[100:115], v[44:47], v[36:39], v[100:115]
    s_lshl_b32 s37, s42, 7
    s_add_u32 m0, s39, 0
    s_add_u32 s37, s37, s62
    buffer_load_dwordx4 v6, s[8:11], s37 offen lds
    s_cmp_lg_u32 s28, 3
    s_cbranch_scc1 K1_STP
    s_mov_b64 exec, 1
    buffer_load_dword v118, v172, s[92:95], 0 offen sc1
    s_mov_b64 exec, -1
K1_STP:
    ds_read_b128 v[36:39], v21 offset:0
    ds_read_b64_tr_b16 v[40:41], v27 offset:2048
    ds_read_b64_tr_b16 v[42:43], v27 offset:2560
    ds_read_b64_tr_b16 v[44:45], v28 offset:2048
    ds_read_b64_tr_b16 v[46:47], v28 offset:2560
    s_waitcnt lgkmcnt(10)
    v_mfma_f32_32x32x16_bf16 v[84:99], v[56:59], v[52:55], v[84:99]
    v_mfma_f32_32x32x16_bf16 v[100:115], v[60:63], v[52:55], v[100:115]
    s_add_u32 m0, s39, 16384
    s_mul_i32 s38, s42, s47
    buffer_load_dwordx4 v8, s[12:15], s38 offen lds
    ds_read_b128 v[52:55], v22 offset:0
    ds_read_b64_tr_b16 v[56:57], v27 offset:4096
    ds_read_b64_tr_b16 v[58:59], v27 offset:4608
    ds_read_b64_tr_b16 v[60:61], v28 offset:4096
    ds_read_b64_tr_b16 v[62:63], v28 offset:4608
    s_waitcnt lgkmcnt(10)
    v_mfma_f32_32x32x16_bf16 v[84:99], v[72:75], v[68:71], v[84:99]
    v_mfma_f32_32x32x16_bf16 v[100:115], v[76:79], v[68:71], v[100:115]
    s_add_u32 m0, s39, 1024
    s_add_u32 s42, s42, 1
    buffer_load_dwordx4 v7, s[8:11], s37 offen lds
    ds_read_b128 v[68:71], v23 offset:0
    ds_read_b64_tr_b16 v[72:73], v27 offset:6144
    ds_read_b64_tr_b16 v[74:75], v27 offset:6656
    ds_read_b64_tr_b16 v[76:77], v28 offset:6144
    ds_read_b64_tr_b16 v[78:79], v28 offset:6656
    s_waitcnt lgkmcnt(10)
    v_mfma_f32_32x32x16_bf16 v[84:99], v[40:43], v[36:39], v[84:99]
    v_mfma_f32_32x32x16_bf16 v[100:115], v[44:47], v[36:39], v[100:115]
    s_add_u32 m0, s39, 17408
    s_add_u32 s38, s38, s46
    buffer_load_dwordx4 v8, s[12:15], s38 offen lds
    s_and_b32 s42, s42, 7
    s_cmp_lg_u32 s28, 3
    s_cbranch_scc1 K1_STS
    s_mov_b64 exec, 1
    s_waitcnt vmcnt(3)
    v_cmp_gt_u32 vcc, 8, v118
    s_cbranch_vccz K1_STR
    s_mov_b32 s41, 12
K1_STRK:
    buffer_load_dword v118, v172, s[92:95], 0 offen sc1
    s_waitcnt vmcnt(0)
    v_cmp_gt_u32 vcc, 8, v118
    s_cbranch_vccz K1_STR
    s_sleep 2
    s_sub_u32 s41, s41, 1
    s_cmp_lg_u32 s41, 0
    s_cbranch_scc1 K1_STRK
    s_mov_b32 s41, 400000
K1_STRL:
    buffer_atomic_umax v118, v172, s[92:95], 0 offen sc0 sc1
    s_sub_u32 s41, s41, 1
    s_cmp_eq_u32 s41, 0
    s_cbranch_scc1 K1_STR
    s_waitcnt vmcnt(0)
    v_cmp_gt_u32 vcc, 8, v118
    s_cbranch_vccz K1_STR
    s_sleep 4
    s_branch K1_STRL
K1_STR:
    s_lshl_b32 s40, s31, 8
    s_add_u32 s40, s40, 0x1b10000
    v_mov_b32 v118, 1
    buffer_atomic_add v118, v172, s[16:19], s40 offen sc1
    s_mov_b64 exec, -1
K1_STS:
    s_waitcnt vmcnt(4)
    s_barrier
    ds_read_b128 v[36:39], v20 offset:32768
    ds_read_b64_tr_b16 v[40:41], v27 offset:32768
    ds_read_b64_tr_b16 v[42:43], v27 offset:33280
    ds_read_b64_tr_b16 v[44:45], v28 offset:32768
    ds_read_b64_tr_b16 v[46:47], v28 offset:33280
    s_waitcnt lgkmcnt(10)
    v_mfma_f32_32x32x16_bf16 v[84:99], v[56:59], v[52:55], v[84:99]
    v_mfma_f32_32x32x16_bf16 v[100:115], v[60:63], v[52:55], v[100:115]
    s_lshl_b32 s37, s42, 7
    s_add_u32 m0, s39, 32768
    s_add_u32 s37, s37, s62
    buffer_load_dwordx4 v6, s[8:11], s37 offen lds
    ds_read_b128 v[52:55], v21 offset:32768
    ds_read_b64_tr_b16 v[56:57], v27 offset:34816
    ds_read_b64_tr_b16 v[58:59], v27 offset:35328
    ds_read_b64_tr_b16 v[60:61], v28 offset:34816
    ds_read_b64_tr_b16 v[62:63], v28 offset:35328
    s_waitcnt lgkmcnt(10)
    v_mfma_f32_32x32x16_bf16 v[84:99], v[72:75], v[68:71], v[84:99]
    v_mfma_f32_32x32x16_bf16 v[100:115], v[76:79], v[68:71], v[100:115]
    s_add_u32 m0, s39, 49152
    s_mul_i32 s38, s42, s47
    buffer_load_dwordx4 v8, s[12:15], s38 offen lds
    ds_read_b128 v[68:71], v22 offset:32768
    ds_read_b64_tr_b16 v[72:73], v27 offset:36864
    ds_read_b64_tr_b16 v[74:75], v27 offset:37376
    ds_read_b64_tr_b16 v[76:77], v28 offset:36864
    ds_read_b64_tr_b16 v[78:79], v28 offset:37376
    s_waitcnt lgkmcnt(10)
    v_mfma_f32_32x32x16_bf16 v[84:99], v[40:43], v[36:39], v[84:99]
    v_mfma_f32_32x32x16_bf16 v[100:115], v[44:47], v[36:39], v[100:115]
    s_add_u32 m0, s39, 33792
    s_add_u32 s42, s42, 1
    buffer_load_dwordx4 v7, s[8:11], s37 offen lds
    ds_read_b128 v[36:39], v23 offset:32768
    ds_read_b64_tr_b16 v[40:41], v27 offset:38912
    ds_read_b64_tr_b16 v[42:43], v27 offset:39424
    ds_read_b64_tr_b16 v[44:45], v28 offset:38912
    ds_read_b64_tr_b16 v[46:47], v28 offset:39424
    s_waitcnt lgkmcnt(10)
    v_mfma_f32_32x32x16_bf16 v[84:99], v[56:59], v[52:55], v[84:99]
    v_mfma_f32_32x32x16_bf16 v[100:115], v[60:63], v[52:55], v[100:115]
    s_add_u32 m0, s39, 50176
    s_add_u32 s38, s38, s46
    buffer_load_dwordx4 v8, s[12:15], s38 offen lds
    s_and_b32 s42, s42, 7
    s_waitcnt vmcnt(4)
    s_barrier
    ds_read_b128 v[52:55], v16 offset:0
    ds_read_b64_tr_b16 v[56:57], v24 offset:0
    ds_read_b64_tr_b16 v[58:59], v24 offset:512
    ds_read_b64_tr_b16 v[60:61], v25 offset:0
    ds_read_b64_tr_b16 v[62:63], v25 offset:512
    s_waitcnt lgkmcnt(10)
    v_mfma_f32_32x32x16_bf16 v[84:99], v[72:75], v[68:71], v[84:99]
    v_mfma_f32_32x32x16_bf16 v[100:115], v[76:79], v[68:71], v[100:115]
    s_lshl_b32 s37, s42, 7
    s_add_u32 m0, s39, 65536
    s_add_u32 s37, s37, s62
    buffer_load_dwordx4 v6, s[8:11], s37 offen lds
    ds_read_b128 v[68:71], v17 offset:0
    ds_read_b64_tr_b16 v[72:73], v24 offset:2048
    ds_read_b64_tr_b16 v[74:75], v24 offset:2560
    ds_read_b64_tr_b16 v[76:77], v25 offset:2048
    ds_read_b64_tr_b16 v[78:79], v25 offset:2560
    s_waitcnt lgkmcnt(10)
    v_mfma_f32_32x32x16_bf16 v[84:99], v[40:43], v[36:39], v[84:99]
    v_mfma_f32_32x32x16_bf16 v[100:115], v[44:47], v[36:39], v[100:115]
    s_add_u32 m0, s39, 81920
    s_mul_i32 s38, s42, s47
    buffer_load_dwordx4 v8, s[12:15], s38 offen lds
    ds_read_b128 v[36:39], v18 offset:0
    ds_read_b64_tr_b16 v[40:41], v24 offset:4096
    ds_read_b64_tr_b16 v[42:43], v24 offset:4608
    ds_read_b64_tr_b16 v[44:45], v25 offset:4096
    ds_read_b64_tr_b16 v[46:47], v25 offset:4608
    s_waitcnt lgkmcnt(10)
    v_mfma_f32_32x32x16_bf16 v[84:99], v[56:59], v[52:55], v[84:99]
    v_mfma_f32_32x32x16_bf16 v[100:115], v[60:63], v[52:55], v[100:115]
    s_add_u32 m0, s39, 66560
    s_add_u32 s42, s42, 1
    buffer_load_dwordx4 v7, s[8:11], s37 offen lds
    ds_read_b128 v[52:55], v19 offset:0
    ds_read_b64_tr_b16 v[56:57], v24 offset:6144
    ds_read_b64_tr_b16 v[58:59], v24 offset:6656
    ds_read_b64_tr_b16 v[60:61], v25 offset:6144
    ds_read_b64_tr_b16 v[62:63], v25 offset:6656
    s_waitcnt lgkmcnt(10)
    v_mfma_f32_32x32x16_bf16 v[84:99], v[72:75], v[68:71], v[84:99]
    v_mfma_f32_32x32x16_bf16 v[100:115], v[76:79], v[68:71], v[100:115]
    s_add_u32 m0, s39, 82944
    s_add_u32 s38, s38, s46
    buffer_load_dwordx4 v8, s[12:15], s38 offen lds
    s_and_b32 s42, s42, 7
    s_waitcnt vmcnt(4)
    s_barrier
    ds_read_b128 v[68:71], v16 offset:32768
    ds_read_b64_tr_b16 v[72:73], v24 offset:32768
    ds_read_b64_tr_b16 v[74:75], v24 offset:33280
    ds_read_b64_tr_b16 v[76:77], v25 offset:32768
    ds_read_b64_tr_b16 v[78:79], v25 offset:33280
    s_waitcnt lgkmcnt(10)
    v_mfma_f32_32x32x16_bf16 v[84:99], v[40:43], v[36:39], v[84:99]
    v_mfma_f32_32x32x16_bf16 v[100:115], v[44:47], v[36:39], v[100:115]
    s_lshl_b32 s37, s42, 7
    s_add_u32 m0, s39, 98304
    s_add_u32 s37, s37, s62
    buffer_load_dwordx4 v6, s[8:11], s37 offen lds
    ds_read_b128 v[36:39], v17 offset:32768
    ds_read_b64_tr_b16 v[40:41], v24 offset:34816
    ds_read_b64_tr_b16 v[42:43], v24 offset:35328
    ds_read_b64_tr_b16 v[44:45], v25 offset:34816
    ds_read_b64_tr_b16 v[46:47], v25 offset:35328
    s_waitcnt lgkmcnt(10)
    v_mfma_f32_32x32x16_bf16 v[84:99], v[56:59], v[52:55], v[84:99]
    v_mfma_f32_32x32x16_bf16 v[100:115], v[60:63], v[52:55], v[100:115]
    s_add_u32 m0, s39, 114688
    s_mul_i32 s38, s42, s47
    buffer_load_dwordx4 v8, s[12:15], s38 offen lds
    ds_read_b128 v[52:55], v18 offset:32768
    ds_read_b64_tr_b16 v[56:57], v24 offset:36864
    ds_read_b64_tr_b16 v[58:59], v24 offset:37376
    ds_read_b64_tr_b16 v[60:61], v25 offset:36864
    ds_read_b64_tr_b16 v[62:63], v25 offset:37376
    s_waitcnt lgkmcnt(10)
    v_mfma_f32_32x32x16_bf16 v[84:99], v[72:75], v[68:71], v[84:99]
    v_mfma_f32_32x32x16_bf16 v[100:115], v[76:79], v[68:71], v[100:115]
    s_add_u32 m0, s39, 99328
    s_add_u32 s42, s42, 1
    buffer_load_dwordx4 v7, s[8:11], s37 offen lds
    ds_read_b128 v[68:71], v19 offset:32768
    ds_read_b64_tr_b16 v[72:73], v24 offset:38912
    ds_read_b64_tr_b16 v[74:75], v24 offset:39424
    ds_read_b64_tr_b16 v[76:77], v25 offset:38912
    ds_read_b64_tr_b16 v[78:79], v25 offset:39424
    s_waitcnt lgkmcnt(10)
    v_mfma_f32_32x32x16_bf16 v[84:99], v[40:43], v[36:39], v[84:99]
    v_mfma_f32_32x32x16_bf16 v[100:115], v[44:47], v[36:39], v[100:115]
    s_add_u32 m0, s39, 115712
    s_add_u32 s38, s38, s46
    buffer_load_dwordx4 v8, s[12:15], s38 offen lds
    s_and_b32 s42, s42, 7
    s_waitcnt vmcnt(4)
    s_barrier
    s_lshl_b32 s40, s31, 2
    s_add_u32 s40, s40, s29
    s_lshl_b32 s40, s40, 8
    s_add_u32 s40, s40, 0x1600000
    v_lshlrev_b32 v2, 3, v9
    buffer_load_dwordx2 v[180:181], v2, s[16:19], s40 offen sc1
    ds_read_b128 v[36:39], v20 offset:0
    ds_read_b64_tr_b16 v[40:41], v27 offset:0
    ds_read_b64_tr_b16 v[42:43], v27 offset:512
    ds_read_b64_tr_b16 v[44:45], v28 offset:0
    ds_read_b64_tr_b16 v[46:47], v28 offset:512
    s_waitcnt lgkmcnt(10)
    v_mfma_f32_32x32x16_bf16 v[84:99], v[56:59], v[52:55], v[84:99]
    v_mfma_f32_32x32x16_bf16 v[100:115], v[60:63], v[52:55], v[100:115]
    ds_read_b128 v[52:55], v21 offset:0
    ds_read_b64_tr_b16 v[56:57], v27 offset:2048
    ds_read_b64_tr_b16 v[58:59], v27 offset:2560
    ds_read_b64_tr_b16 v[60:61], v28 offset:2048
    ds_read_b64_tr_b16 v[62:63], v28 offset:2560
    s_waitcnt lgkmcnt(10)
    v_mfma_f32_32x32x16_bf16 v[84:99], v[72:75], v[68:71], v[84:99]
    v_mfma_f32_32x32x16_bf16 v[100:115], v[76:79], v[68:71], v[100:115]
    ds_read_b128 v[68:71], v22 offset:0
    ds_read_b64_tr_b16 v[72:73], v27 offset:4096
    ds_read_b64_tr_b16 v[74:75], v27 offset:4608
    ds_read_b64_tr_b16 v[76:77], v28 offset:4096
    ds_read_b64_tr_b16 v[78:79], v28 offset:4608
    s_waitcnt lgkmcnt(10)
    v_mfma_f32_32x32x16_bf16 v[84:99], v[40:43], v[36:39], v[84:99]
    v_mfma_f32_32x32x16_bf16 v[100:115], v[44:47], v[36:39], v[100:115]
    ds_read_b128 v[36:39], v23 offset:0
    ds_read_b64_tr_b16 v[40:41], v27 offset:6144
    ds_read_b64_tr_b16 v[42:43], v27 offset:6656
    ds_read_b64_tr_b16 v[44:45], v28 offset:6144
    ds_read_b64_tr_b16 v[46:47], v28 offset:6656
    s_waitcnt lgkmcnt(10)
    v_mfma_f32_32x32x16_bf16 v[84:99], v[56:59], v[52:55], v[84:99]
    v_mfma_f32_32x32x16_bf16 v[100:115], v[60:63], v[52:55], v[100:115]
    s_waitcnt vmcnt(1)
    s_barrier
    ds_read_b128 v[52:55], v20 offset:32768
    ds_read_b64_tr_b16 v[56:57], v27 offset:32768
    ds_read_b64_tr_b16 v[58:59], v27 offset:33280
    ds_read_b64_tr_b16 v[60:61], v28 offset:32768
    ds_read_b64_tr_b16 v[62:63], v28 offset:33280
    s_waitcnt lgkmcnt(10)
    v_mfma_f32_32x32x16_bf16 v[84:99], v[72:75], v[68:71], v[84:99]
    v_mfma_f32_32x32x16_bf16 v[100:115], v[76:79], v[68:71], v[100:115]
    buffer_load_dwordx4 v[196:199], v11, s[48:51], s63 offen
    buffer_load_dwordx4 v[200:203], v11, s[48:51], s4 offen
    ds_read_b128 v[68:71], v21 offset:32768
    ds_read_b64_tr_b16 v[72:73], v27 offset:34816
    ds_read_b64_tr_b16 v[74:75], v27 offset:35328
    ds_read_b64_tr_b16 v[76:77], v28 offset:34816
    ds_read_b64_tr_b16 v[78:79], v28 offset:35328
    s_waitcnt lgkmcnt(10)
    v_mfma_f32_32x32x16_bf16 v[84:99], v[40:43], v[36:39], v[84:99]
    v_mfma_f32_32x32x16_bf16 v[100:115], v[44:47], v[36:39], v[100:115]
    v_lshlrev_b32 v2, 2, v0
    v_mov_b32 v3, 0
    ds_write_b32 v2, v3 offset:33280
    ds_write_b32 v2, v3 offset:33536
    ds_read_b128 v[36:39], v22 offset:32768
    ds_read_b64_tr_b16 v[40:41], v27 offset:36864
    ds_read_b64_tr_b16 v[42:43], v27 offset:37376
    ds_read_b64_tr_b16 v[44:45], v28 offset:36864
    ds_read_b64_tr_b16 v[46:47], v28 offset:37376
    s_waitcnt lgkmcnt(10)
    v_mfma_f32_32x32x16_bf16 v[84:99], v[56:59], v[52:55], v[84:99]
    v_mfma_f32_32x32x16_bf16 v[100:115], v[60:63], v[52:55], v[100:115]
    ds_read_b128 v[52:55], v23 offset:32768
    ds_read_b64_tr_b16 v[56:57], v27 offset:38912
    ds_read_b64_tr_b16 v[58:59], v27 offset:39424
    ds_read_b64_tr_b16 v[60:61], v28 offset:38912
    ds_read_b64_tr_b16 v[62:63], v28 offset:39424
    s_waitcnt lgkmcnt(10)
    v_mfma_f32_32x32x16_bf16 v[84:99], v[72:75], v[68:71], v[84:99]
    v_mfma_f32_32x32x16_bf16 v[100:115], v[76:79], v[68:71], v[100:115]
    s_waitcnt lgkmcnt(5)
    v_mfma_f32_32x32x16_bf16 v[84:99], v[40:43], v[36:39], v[84:99]
    v_mfma_f32_32x32x16_bf16 v[100:115], v[44:47], v[36:39], v[100:115]
    s_waitcnt lgkmcnt(0)
    v_mfma_f32_32x32x16_bf16 v[84:99], v[56:59], v[52:55], v[84:99]
    v_mfma_f32_32x32x16_bf16 v[100:115], v[60:63], v[52:55], v[100:115]
    s_waitcnt vmcnt(2)
    s_branch K1_JOIN
K1_B1:
    s_waitcnt vmcnt(5)
    s_barrier
    ds_read_b128 v[36:39], v16 offset:0
    ds_read_b64_tr_b16 v[40:41], v24 offset:0
    ds_read_b64_tr_b16 v[42:43], v24 offset:512
    ds_read_b64_tr_b16 v[44:45], v25 offset:0
    ds_read_b64_tr_b16 v[46:47], v25 offset:512
    ds_read_b64_tr_b16 v[48:49], v26 offset:0
    ds_read_b64_tr_b16 v[50:51], v26 offset:512
    ds_read_b128 v[52:55], v17 offset:0
    ds_read_b64_tr_b16 v[56:57], v24 offset:2048
    ds_read_b64_tr_b16 v[58:59], v24 offset:2560
    ds_read_b64_tr_b16 v[60:61], v25 offset:2048
    ds_read_b64_tr_b16 v[62:63], v25 offset:2560
    ds_read_b64_tr_b16 v[64:65], v26 offset:2048
    ds_read_b64_tr_b16 v[66:67], v26 offset:2560
    ds_read_b128 v[68:71], v18 offset:0
    ds_read_b64_tr_b16 v[72:73], v24 offset:4096
    ds_read_b64_tr_b16 v[74:75], v24 offset:4608
    ds_read_b64_tr_b16 v[76:77], v25 offset:4096
    ds_read_b64_tr_b16 v[78:79], v25 offset:4608
    ds_read_b64_tr_b16 v[80:81], v26 offset:4096
    ds_read_b64_tr_b16 v[82:83], v26 offset:4608
    s_waitcnt lgkmcnt(14)
    v_mfma_f32_32x32x16_bf16 v[84:99], v[40:43], v[36:39], 0
    v_mfma_f32_32x32x16_bf16 v[100:115], v[44:47], v[36:39], 0
    v_mfma_f32_16x16x32_bf16 v[120:123], v[32:35], v[48:51], 0
    s_lshl_b32 s37, s42, 7
    s_add_u32 m0, s39, 65536
    s_add_u32 s37, s37, s62
    buffer_load_dwordx4 v6, s[8:11], s37 offen lds
    s_add_u32 m0, s39, 81920
    s_mul_i32 s38, s42, s47
    buffer_load_dwordx4 v8, s[12:15], s38 offen lds
    ds_read_b128 v[36:39], v19 offset:0
    ds_read_b64_tr_b16 v[40:41], v24 offset:6144
    ds_read_b64_tr_b16 v[42:43], v24 offset:6656
    ds_read_b64_tr_b16 v[44:45], v25 offset:6144
    ds_read_b64_tr_b16 v[46:47], v25 offset:6656
    ds_read_b64_tr_b16 v[48:49], v26 offset:6144
    ds_read_b64_tr_b16 v[50:51], v26 offset:6656
    s_waitcnt lgkmcnt(14)
    v_mfma_f32_32x32x16_bf16 v[84:99], v[56:59], v[52:55], v[84:99]
    v_mfma_f32_32x32x16_bf16 v[100:115], v[60:63], v[52:55], v[100:115]
    v_mfma_f32_16x16x32_bf16 v[120:123], v[32:35], v[64:67], v[120:123]
    s_add_u32 m0, s39, 66560
    s_add_u32 s42, s42, 1
    buffer_load_dwordx4 v7, s[8:11], s37 offen lds
    s_add_u32 m0, s39, 82944
    s_add_u32 s38, s38, s46
    buffer_load_dwordx4 v8, s[12:15], s38 offen lds
    s_and_b32 s42, s42, 7
    s_waitcnt vmcnt(5)
    s_barrier
    ds_read_b128 v[52:55], v16 offset:32768
    ds_read_b64_tr_b16 v[56:57], v24 offset:32768
    ds_read_b64_tr_b16 v[58:59], v24 offset:33280
    ds_read_b64_tr_b16 v[60:61], v25 offset:32768
    ds_read_b64_tr_b16 v[62:63], v25 offset:33280
    ds_read_b64_tr_b16 v[64:65], v26 offset:32768
    ds_read_b64_tr_b16 v[66:67], v26 offset:33280
    s_waitcnt lgkmcnt(14)
    v_mfma_f32_32x32x16_bf16 v[84:99], v[72:75], v[68:71], v[84:99]
    v_mfma_f32_32x32x16_bf16 v[100:115], v[76:79], v[68:71], v[100:115]
    v_mfma_f32_16x16x32_bf16 v[120:123], v[32:35], v[80:83], v[120:123]
    s_lshl_b32 s37, s42, 7
    s_add_u32 m0, s39, 98304
    s_add_u32 s37, s37, s62
    buffer_load_dwordx4 v6, s[8:11], s37 offen lds
    ds_read_b128 v[68:71], v17 offset:32768
    ds_read_b64_tr_b16 v[72:73], v24 offset:34816
    ds_read_b64_tr_b16 v[74:75], v24 offset:35328
    ds_read_b64_tr_b16 v[76:77], v25 offset:34816
    ds_read_b64_tr_b16 v[78:79], v25 offset:35328
    ds_read_b64_tr_b16 v[80:81], v26 offset:34816
    ds_read_b64_tr_b16 v[82:83], v26 offset:35328
    s_waitcnt lgkmcnt(14)
    v_mfma_f32_32x32x16_bf16 v[84:99], v[40:43], v[36:39], v[84:99]
    v_mfma_f32_32x32x16_bf16 v[100:115], v[44:47], v[36:39], v[100:115]
    v_mfma_f32_16x16x32_bf16 v[120:123], v[32:35], v[48:51], v[120:123]
    s_add_u32 m0, s39, 114688
    s_mul_i32 s38, s42, s47
    buffer_load_dwordx4 v8, s[12:15], s38 offen lds
    ds_read_b128 v[36:39], v18 offset:32768
    ds_read_b64_tr_b16 v[40:41], v24 offset:36864
    ds_read_b64_tr_b16 v[42:43], v24 offset:37376
    ds_read_b64_tr_b16 v[44:45], v25 offset:36864
    ds_read_b64_tr_b16 v[46:47], v25 offset:37376
    ds_read_b64_tr_b16 v[48:49], v26 offset:36864
    ds_read_b64_tr_b16 v[50:51], v26 offset:37376
    s_waitcnt lgkmcnt(14)
    v_mfma_f32_32x32x16_bf16 v[84:99], v[56:59], v[52:55], v[84:99]
    v_mfma_f32_32x32x16_bf16 v[100:115], v[60:63], v[52:55], v[100:115]
    v_mfma_f32_16x16x32_bf16 v[120:123], v[32:35], v[64:67], v[120:123]
    s_add_u32 m0, s39, 99328
    s_add_u32 s42, s42, 1
    buffer_load_dwordx4 v7, s[8:11], s37 offen lds
    ds_read_b128 v[52:55], v19 offset:32768
    ds_read_b64_tr_b16 v[56:57], v24 offset:38912
    ds_read_b64_tr_b16 v[58:59], v24 offset:39424
    ds_read_b64_tr_b16 v[60:61], v25 offset:38912
    ds_read_b64_tr_b16 v[62:63], v25 offset:39424
    ds_read_b64_tr_b16 v[64:65], v26 offset:38912
    ds_read_b64_tr_b16 v[66:67], v26 offset:39424
    s_waitcnt lgkmcnt(14)
    v_mfma_f32_32x32x16_bf16 v[84:99], v[72:75], v[68:71], v[84:99]
    v_mfma_f32_32x32x16_bf16 v[100:115], v[76:79], v[68:71], v[100:115]
    v_mfma_f32_16x16x32_bf16 v[120:123], v[32:35], v[80:83], v[120:123]
    s_add_u32 m0, s39, 115712
    s_add_u32 s38, s38, s46
    buffer_load_dwordx4 v8, s[12:15], s38 offen lds
    s_and_b32 s42, s42, 7
    s_waitcnt vmcnt(4)
    s_barrier
    ds_read_b128 v[68:71], v20 offset:0
    ds_read_b64_tr_b16 v[72:73], v27 offset:0
    ds_read_b64_tr_b16 v[74:75], v27 offset:512
    ds_read_b64_tr_b16 v[76:77], v28 offset:0
    ds_read_b64_tr_b16 v[78:79], v28 offset:512
    ds_read_b64_tr_b16 v[80:81], v29 offset:0
    ds_read_b64_tr_b16 v[82:83], v29 offset:512
    s_waitcnt lgkmcnt(14)
    v_mfma_f32_32x32x16_bf16 v[84:99], v[40:43], v[36:39], v[84:99]
    v_mfma_f32_32x32x16_bf16 v[100:115], v[44:47], v[36:39], v[100:115]
    v_mfma_f32_16x16x32_bf16 v[120:123], v[32:35], v[48:51], v[120:123]
    s_lshl_b32 s37, s42, 7
    s_add_u32 m0, s39, 0
    s_add_u32 s37, s37, s62
    buffer_load_dwordx4 v6, s[8:11], s37 offen lds
    ds_read_b128 v[36:39], v21 offset:0
    ds_read_b64_tr_b16 v[40:41], v27 offset:2048
    ds_read_b64_tr_b16 v[42:43], v27 offset:2560
    ds_read_b64_tr_b16 v[44:45], v28 offset:2048
    ds_read_b64_tr_b16 v[46:47], v28 offset:2560
    ds_read_b64_tr_b16 v[48:49], v29 offset:2048
    ds_read_b64_tr_b16 v[50:51], v29 offset:2560
    s_waitcnt lgkmcnt(14)
    v_mfma_f32_32x32x16_bf16 v[84:99], v[56:59], v[52:55], v[84:99]
    v_mfma_f32_32x32x16_bf16 v[100:115], v[60:63], v[52:55], v[100:115]
    v_mfma_f32_16x16x32_bf16 v[120:123], v[32:35], v[64:67], v[120:123]
    s_add_u32 m0, s39, 16384
    s_mul_i32 s38, s42, s47
    buffer_load_dwordx4 v8, s[12:15], s38 offen lds
    ds_read_b128 v[52:55], v22 offset:0
    ds_read_b64_tr_b16 v[56:57], v27 offset:4096
    ds_read_b64_tr_b16 v[58:59], v27 offset:4608
    ds_read_b64_tr_b16 v[60:61], v28 offset:4096
    ds_read_b64_tr_b16 v[62:63], v28 offset:4608
    ds_read_b64_tr_b16 v[64:65], v29 offset:4096
    ds_read_b64_tr_b16 v[66:67], v29 offset:4608
    s_waitcnt lgkmcnt(14)
    v_mfma_f32_32x32x16_bf16 v[84:99], v[72:75], v[68:71], v[84:99]
    v_mfma_f32_32x32x16_bf16 v[100:115], v[76:79], v[68:71], v[100:115]
    v_mfma_f32_16x16x32_bf16 v[120:123], v[32:35], v[80:83], v[120:123]
    s_add_u32 m0, s39, 1024
    s_add_u32 s42, s42, 1
    buffer_load_dwordx4 v7, s[8:11], s37 offen lds
    ds_read_b128 v[68:71], v23 offset:0
    ds_read_b64_tr_b16 v[72:73], v27 offset:6144
    ds_read_b64_tr_b16 v[74:75], v27 offset:6656
    ds_read_b64_tr_b16 v[76:77], v28 offset:6144
    ds_read_b64_tr_b16 v[78:79], v28 offset:6656
    ds_read_b64_tr_b16 v[80:81], v29 offset:6144
    ds_read_b64_tr_b16 v[82:83], v29 offset:6656
    s_waitcnt lgkmcnt(14)
    v_mfma_f32_32x32x16_bf16 v[84:99], v[40:43], v[36:39], v[84:99]
    v_mfma_f32_32x32x16_bf16 v[100:115], v[44:47], v[36:39], v[100:115]
    v_mfma_f32_16x16x32_bf16 v[120:123], v[32:35], v[48:51], v[120:123]
    s_add_u32 m0, s39, 17408
    s_add_u32 s38, s38, s46
    buffer_load_dwordx4 v8, s[12:15], s38 offen lds
    s_and_b32 s42, s42, 7
    s_waitcnt vmcnt(4)
    s_barrier
    ds_read_b128 v[36:39], v20 offset:32768
    ds_read_b64_tr_b16 v[40:41], v27 offset:32768
    ds_read_b64_tr_b16 v[42:43], v27 offset:33280
    ds_read_b64_tr_b16 v[44:45], v28 offset:32768
    ds_read_b64_tr_b16 v[46:47], v28 offset:33280
    ds_read_b64_tr_b16 v[48:49], v29 offset:32768
    ds_read_b64_tr_b16 v[50:51], v29 offset:33280
    s_waitcnt lgkmcnt(14)
    v_mfma_f32_32x32x16_bf16 v[84:99], v[56:59], v[52:55], v[84:99]
    v_mfma_f32_32x32x16_bf16 v[100:115], v[60:63], v[52:55], v[100:115]
    v_mfma_f32_16x16x32_bf16 v[120:123], v[32:35], v[64:67], v[120:123]
    s_lshl_b32 s37, s42, 7
    s_add_u32 m0, s39, 32768
    s_add_u32 s37, s37, s62
    buffer_load_dwordx4 v6, s[8:11], s37 offen lds
    ds_read_b128 v[52:55], v21 offset:32768
    ds_read_b64_tr_b16 v[56:57], v27 offset:34816
    ds_read_b64_tr_b16 v[58:59], v27 offset:35328
    ds_read_b64_tr_b16 v[60:61], v28 offset:34816
    ds_read_b64_tr_b16 v[62:63], v28 offset:35328
    ds_read_b64_tr_b16 v[64:65], v29 offset:34816
    ds_read_b64_tr_b16 v[66:67], v29 offset:35328
    s_waitcnt lgkmcnt(14)
    v_mfma_f32_32x32x16_bf16 v[84:99], v[72:75], v[68:71], v[84:99]
    v_mfma_f32_32x32x16_bf16 v[100:115], v[76:79], v[68:71], v[100:115]
    v_mfma_f32_16x16x32_bf16 v[120:123], v[32:35], v[80:83], v[120:123]
    s_add_u32 m0, s39, 49152
    s_mul_i32 s38, s42, s47
    buffer_load_dwordx4 v8, s[12:15], s38 offen lds
    ds_read_b128 v[68:71], v22 offset:32768
    ds_read_b64_tr_b16 v[72:73], v27 offset:36864
    ds_read_b64_tr_b16 v[74:75], v27 offset:37376
    ds_read_b64_tr_b16 v[76:77], v28 offset:36864
    ds_read_b64_tr_b16 v[78:79], v28 offset:37376
    ds_read_b64_tr_b16 v[80:81], v29 offset:36864
    ds_read_b64_tr_b16 v[82:83], v29 offset:37376
    s_waitcnt lgkmcnt(14)
    v_mfma_f32_32x32x16_bf16 v[84:99], v[40:43], v[36:39], v[84:99]
    v_mfma_f32_32x32x16_bf16 v[100:115], v[44:47], v[36:39], v[100:115]
    v_mfma_f32_16x16x32_bf16 v[120:123], v[32:35], v[48:51], v[120:123]
    s_add_u32 m0, s39, 33792
    s_add_u32 s42, s42, 1
    buffer_load_dwordx4 v7, s[8:11], s37 offen lds
    ds_read_b128 v[36:39], v23 offset:32768
    ds_read_b64_tr_b16 v[40:41], v27 offset:38912
    ds_read_b64_tr_b16 v[42:43], v27 offset:39424
    ds_read_b64_tr_b16 v[44:45], v28 offset:38912
    ds_read_b64_tr_b16 v[46:47], v28 offset:39424
    ds_read_b64_tr_b16 v[48:49], v29 offset:38912
    ds_read_b64_tr_b16 v[50:51], v29 offset:39424
    s_waitcnt lgkmcnt(14)
    v_mfma_f32_32x32x16_bf16 v[84:99], v[56:59], v[52:55], v[84:99]
    v_mfma_f32_32x32x16_bf16 v[100:115], v[60:63], v[52:55], v[100:115]
    v_mfma_f32_16x16x32_bf16 v[120:123], v[32:35], v[64:67], v[120:123]
    s_add_u32 m0, s39, 50176
    s_add_u32 s38, s38, s46
    buffer_load_dwordx4 v8, s[12:15], s38 offen lds
    s_and_b32 s42, s42, 7
    s_waitcnt vmcnt(4)
    s_barrier
    ds_read_b128 v[52:55], v16 offset:0
    ds_read_b64_tr_b16 v[56:57], v24 offset:0
    ds_read_b64_tr_b16 v[58:59], v24 offset:512
    ds_read_b64_tr_b16 v[60:61], v25 offset:0
    ds_read_b64_tr_b16 v[62:63], v25 offset:512
    ds_read_b64_tr_b16 v[64:65], v26 offset:0
    ds_read_b64_tr_b16 v[66:67], v26 offset:512
    s_waitcnt lgkmcnt(14)
    v_mfma_f32_32x32x16_bf16 v[84:99], v[72:75], v[68:71], v[84:99]
    v_mfma_f32_32x32x16_bf16 v[100:115], v[76:79], v[68:71], v[100:115]
    v_mfma_f32_16x16x32_bf16 v[120:123], v[32:35], v[80:83], v[120:123]
    s_lshl_b32 s37, s42, 7
    s_add_u32 m0, s39, 65536
    s_add_u32 s37, s37, s62
    buffer_load_dwordx4 v6, s[8:11], s37 offen lds
    ds_read_b128 v[68:71], v17 offset:0
    ds_read_b64_tr_b16 v[72:73], v24 offset:2048
    ds_read_b64_tr_b16 v[74:75], v24 offset:2560
    ds_read_b64_tr_b16 v[76:77], v25 offset:2048
    ds_read_b64_tr_b16 v[78:79], v25 offset:2560
    ds_read_b64_tr_b16 v[80:81], v26 offset:2048
    ds_read_b64_tr_b16 v[82:83], v26 offset:2560
    s_waitcnt lgkmcnt(14)
    v_mfma_f32_32x32x16_bf16 v[84:99], v[40:43], v[36:39], v[84:99]
    v_mfma_f32_32x32x16_bf16 v[100:115], v[44:47], v[36:39], v[100:115]
    v_mfma_f32_16x16x32_bf16 v[120:123], v[32:35], v[48:51], v[120:123]
    s_add_u32 m0, s39, 81920
    s_mul_i32 s38, s42, s47
    buffer_load_dwordx4 v8, s[12:15], s38 offen lds
    ds_read_b128 v[36:39], v18 offset:0
    ds_read_b64_tr_b16 v[40:41], v24 offset:4096
    ds_read_b64_tr_b16 v[42:43], v24 offset:4608
    ds_read_b64_tr_b16 v[44:45], v25 offset:4096
    ds_read_b64_tr_b16 v[46:47], v25 offset:4608
    ds_read_b64_tr_b16 v[48:49], v26 offset:4096
    ds_read_b64_tr_b16 v[50:51], v26 offset:4608
    s_waitcnt lgkmcnt(14)
    v_mfma_f32_32x32x16_bf16 v[84:99], v[56:59], v[52:55], v[84:99]
    v_mfma_f32_32x32x16_bf16 v[100:115], v[60:63], v[52:55], v[100:115]
    v_mfma_f32_16x16x32_bf16 v[120:123], v[32:35], v[64:67], v[120:123]
    s_add_u32 m0, s39, 66560
    s_add_u32 s42, s42, 1
    buffer_load_dwordx4 v7, s[8:11], s37 offen lds
    s_cmp_lg_u32 s28, 7
    s_cbranch_scc1 K1_STQ
    s_lshl_b32 s40, s31, 8
    s_add_u32 s40, s40, 0x1b10000
    s_mov_b64 exec, 1
    buffer_atomic_umax v118, v172, s[16:19], s40 offen sc0 sc1
    s_mov_b64 exec, -1
K1_STQ:
    ds_read_b128 v[52:55], v19 offset:0
    ds_read_b64_tr_b16 v[56:57], v24 offset:6144
    ds_read_b64_tr_b16 v[58:59], v24 offset:6656
    ds_read_b64_tr_b16 v[60:61], v25 offset:6144
    ds_read_b64_tr_b16 v[62:63], v25 offset:6656
    ds_read_b64_tr_b16 v[64:65], v26 offset:6144
    ds_read_b64_tr_b16 v[66:67], v26 offset:6656
    s_waitcnt lgkmcnt(14)
    v_mfma_f32_32x32x16_bf16 v[84:99], v[72:75], v[68:71], v[84:99]
    v_mfma_f32_32x32x16_bf16 v[100:115], v[76:79], v[68:71], v[100:115]
    v_mfma_f32_16x16x32_bf16 v[120:123], v[32:35], v[80:83], v[120:123]
    s_add_u32 m0, s39, 82944
    s_add_u32 s38, s38, s46
    buffer_load_dwordx4 v8, s[12:15], s38 offen lds
    s_and_b32 s42, s42, 7
    s_waitcnt vmcnt(4)
    s_barrier
    ds_read_b128 v[68:71], v16 offset:32768
    ds_read_b64_tr_b16 v[72:73], v24 offset:32768
    ds_read_b64_tr_b16 v[74:75], v24 offset:33280
    ds_read_b64_tr_b16 v[76:77], v25 offset:32768
    ds_read_b64_tr_b16 v[78:79], v25 offset:33280
    ds_read_b64_tr_b16 v[80:81], v26 offset:32768
    ds_read_b64_tr_b16 v[82:83], v26 offset:33280
    s_waitcnt lgkmcnt(14)
    v_mfma_f32_32x32x16_bf16 v[84:99], v[40:43], v[36:39], v[84:99]
    v_mfma_f32_32x32x16_bf16 v[100:115], v[44:47], v[36:39], v[100:115]
    v_mfma_f32_16x16x32_bf16 v[120:123], v[32:35], v[48:51], v[120:123]
    s_lshl_b32 s37, s42, 7
    s_add_u32 m0, s39, 98304
    s_add_u32 s37, s37, s62
    buffer_load_dwordx4 v6, s[8:11], s37 offen lds
    ds_read_b128 v[36:39], v17 offset:32768
    ds_read_b64_tr_b16 v[40:41], v24 offset:34816
    ds_read_b64_tr_b16 v[42:43], v24 offset:35328
    ds_read_b64_tr_b16 v[44:45], v25 offset:34816
    ds_read_b64_tr_b16 v[46:47], v25 offset:35328
    ds_read_b64_tr_b16 v[48:49], v26 offset:34816
    ds_read_b64_tr_b16 v[50:51], v26 offset:35328
    s_waitcnt lgkmcnt(14)
    v_mfma_f32_32x32x16_bf16 v[84:99], v[56:59], v[52:55], v[84:99]
    v_mfma_f32_32x32x16_bf16 v[100:115], v[60:63], v[52:55], v[100:115]
    v_mfma_f32_16x16x32_bf16 v[120:123], v[32:35], v[64:67], v[120:123]
    s_add_u32 m0, s39, 114688
    s_mul_i32 s38, s42, s47
    buffer_load_dwordx4 v8, s[12:15], s38 offen lds
    ds_read_b128 v[52:55], v18 offset:32768
    ds_read_b64_tr_b16 v[56:57], v24 offset:36864
    ds_read_b64_tr_b16 v[58:59], v24 offset:37376
    ds_read_b64_tr_b16 v[60:61], v25 offset:36864
    ds_read_b64_tr_b16 v[62:63], v25 offset:37376
    ds_read_b64_tr_b16 v[64:65], v26 offset:36864
    ds_read_b64_tr_b16 v[66:67], v26 offset:37376
    s_waitcnt lgkmcnt(14)
    v_mfma_f32_32x32x16_bf16 v[84:99], v[72:75], v[68:71], v[84:99]
    v_mfma_f32_32x32x16_bf16 v[100:115], v[76:79], v[68:71], v[100:115]
    v_mfma_f32_16x16x32_bf16 v[120:123], v[32:35], v[80:83], v[120:123]
    s_add_u32 m0, s39, 99328
    s_add_u32 s42, s42, 1
    buffer_load_dwordx4 v7, s[8:11], s37 offen lds
    ds_read_b128 v[68:71], v19 offset:32768
    ds_read_b64_tr_b16 v[72:73], v24 offset:38912
    ds_read_b64_tr_b16 v[74:75], v24 offset:39424
    ds_read_b64_tr_b16 v[76:77], v25 offset:38912
    ds_read_b64_tr_b16 v[78:79], v25 offset:39424
    ds_read_b64_tr_b16 v[80:81], v26 offset:38912
    ds_read_b64_tr_b16 v[82:83], v26 offset:39424
    s_waitcnt lgkmcnt(14)
    v_mfma_f32_32x32x16_bf16 v[84:99], v[40:43], v[36:39], v[84:99]
    v_mfma_f32_32x32x16_bf16 v[100:115], v[44:47], v[36:39], v[100:115]
    v_mfma_f32_16x16x32_bf16 v[120:123], v[32:35], v[48:51], v[120:123]
    s_add_u32 m0, s39, 115712
    s_add_u32 s38, s38, s46
    buffer_load_dwordx4 v8, s[12:15], s38 offen lds
    s_and_b32 s42, s42, 7
    s_waitcnt vmcnt(4)
    s_cmp_lg_u32 s28, 7
    s_cbranch_scc1 K1_STX
    s_mov_b64 exec, 1
    s_waitcnt vmcnt(4)
    v_cmp_gt_u32 vcc, 16, v118
    s_cbranch_vccz K1_STW
    s_mov_b32 s41, 400000
K1_STWL:
    buffer_atomic_umax v118, v172, s[16:19], s40 offen sc0 sc1
    s_sub_u32 s41, s41, 1
    s_cmp_eq_u32 s41, 0
    s_cbranch_scc1 K1_STW
    s_waitcnt vmcnt(0)
    v_cmp_gt_u32 vcc, 16, v118
    s_cbranch_vccz K1_STW
    s_sleep 4
    s_branch K1_STWL
K1_STW:
    s_mov_b64 exec, -1
K1_STX:
    s_barrier
    s_lshl_b32 s40, s31, 2
    s_add_u32 s40, s40, s29
    s_lshl_b32 s40, s40, 8
    s_add_u32 s40, s40, 0x1600000
    v_lshlrev_b32 v2, 3, v9
    buffer_load_dwordx2 v[180:181], v2, s[16:19], s40 offen sc1
    ds_read_b128 v[36:39], v20 offset:0
    ds_read_b64_tr_b16 v[40:41], v27 offset:0
    ds_read_b64_tr_b16 v[42:43], v27 offset:512
    ds_read_b64_tr_b16 v[44:45], v28 offset:0
    ds_read_b64_tr_b16 v[46:47], v28 offset:512
    ds_read_b64_tr_b16 v[48:49], v29 offset:0
    ds_read_b64_tr_b16 v[50:51], v29 offset:512
    s_waitcnt lgkmcnt(14)
    v_mfma_f32_32x32x16_bf16 v[84:99], v[56:59], v[52:55], v[84:99]
    v_mfma_f32_32x32x16_bf16 v[100:115], v[60:63], v[52:55], v[100:115]
    v_mfma_f32_16x16x32_bf16 v[120:123], v[32:35], v[64:67], v[120:123]
    ds_read_b128 v[52:55], v21 offset:0
    ds_read_b64_tr_b16 v[56:57], v27 offset:2048
    ds_read_b64_tr_b16 v[58:59], v27 offset:2560
    ds_read_b64_tr_b16 v[60:61], v28 offset:2048
    ds_read_b64_tr_b16 v[62:63], v28 offset:2560
    ds_read_b64_tr_b16 v[64:65], v29 offset:2048
    ds_read_b64_tr_b16 v[66:67], v29 offset:2560
    s_waitcnt lgkmcnt(14)
    v_mfma_f32_32x32x16_bf16 v[84:99], v[72:75], v[68:71], v[84:99]
    v_mfma_f32_32x32x16_bf16 v[100:115], v[76:79], v[68:71], v[100:115]
    v_mfma_f32_16x16x32_bf16 v[120:123], v[32:35], v[80:83], v[120:123]
    ds_read_b128 v[68:71], v22 offset:0
    ds_read_b64_tr_b16 v[72:73], v27 offset:4096
    ds_read_b64_tr_b16 v[74:75], v27 offset:4608
    ds_read_b64_tr_b16 v[76:77], v28 offset:4096
    ds_read_b64_tr_b16 v[78:79], v28 offset:4608
    ds_read_b64_tr_b16 v[80:81], v29 offset:4096
    ds_read_b64_tr_b16 v[82:83], v29 offset:4608
    s_waitcnt lgkmcnt(14)
    v_mfma_f32_32x32x16_bf16 v[84:99], v[40:43], v[36:39], v[84:99]
    v_mfma_f32_32x32x16_bf16 v[100:115], v[44:47], v[36:39], v[100:115]
    v_mfma_f32_16x16x32_bf16 v[120:123], v[32:35], v[48:51], v[120:123]
    ds_read_b128 v[36:39], v23 offset:0
    ds_read_b64_tr_b16 v[40:41], v27 offset:6144
    ds_read_b64_tr_b16 v[42:43], v27 offset:6656
    ds_read_b64_tr_b16 v[44:45], v28 offset:6144
    ds_read_b64_tr_b16 v[46:47], v28 offset:6656
    ds_read_b64_tr_b16 v[48:49], v29 offset:6144
    ds_read_b64_tr_b16 v[50:51], v29 offset:6656
    s_waitcnt lgkmcnt(14)
    v_mfma_f32_32x32x16_bf16 v[84:99], v[56:59], v[52:55], v[84:99]
    v_mfma_f32_32x32x16_bf16 v[100:115], v[60:63], v[52:55], v[100:115]
    v_mfma_f32_16x16x32_bf16 v[120:123], v[32:35], v[64:67], v[120:123]
    s_waitcnt vmcnt(1)
    s_barrier
    ds_read_b128 v[52:55], v20 offset:32768
    ds_read_b64_tr_b16 v[56:57], v27 offset:32768
    ds_read_b64_tr_b16 v[58:59], v27 offset:33280
    ds_read_b64_tr_b16 v[60:61], v28 offset:32768
    ds_read_b64_tr_b16 v[62:63], v28 offset:33280
    ds_read_b64_tr_b16 v[64:65], v29 offset:32768
    ds_read_b64_tr_b16 v[66:67], v29 offset:33280
    s_waitcnt lgkmcnt(14)
    v_mfma_f32_32x32x16_bf16 v[84:99], v[72:75], v[68:71], v[84:99]
    v_mfma_f32_32x32x16_bf16 v[100:115], v[76:79], v[68:71], v[100:115]
    v_mfma_f32_16x16x32_bf16 v[120:123], v[32:35], v[80:83], v[120:123]
    buffer_load_dwordx4 v[196:199], v11, s[48:51], s63 offen
    buffer_load_dwordx4 v[200:203], v11, s[48:51], s4 offen
    ds_read_b128 v[68:71], v21 offset:32768
    ds_read_b64_tr_b16 v[72:73], v27 offset:34816
    ds_read_b64_tr_b16 v[74:75], v27 offset:35328
    ds_read_b64_tr_b16 v[76:77], v28 offset:34816
    ds_read_b64_tr_b16 v[78:79], v28 offset:35328
    ds_read_b64_tr_b16 v[80:81], v29 offset:34816
    ds_read_b64_tr_b16 v[82:83], v29 offset:35328
    s_waitcnt lgkmcnt(14)
    v_mfma_f32_32x32x16_bf16 v[84:99], v[40:43], v[36:39], v[84:99]
    v_mfma_f32_32x32x16_bf16 v[100:115], v[44:47], v[36:39], v[100:115]
    v_mfma_f32_16x16x32_bf16 v[120:123], v[32:35], v[48:51], v[120:123]
    v_lshlrev_b32 v2, 2, v0
    v_mov_b32 v3, 0
    ds_write_b32 v2, v3 offset:33280
    ds_write_b32 v2, v3 offset:33536
    ds_read_b128 v[36:39], v22 offset:32768
    ds_read_b64_tr_b16 v[40:41], v27 offset:36864
    ds_read_b64_tr_b16 v[42:43], v27 offset:37376
    ds_read_b64_tr_b16 v[44:45], v28 offset:36864
    ds_read_b64_tr_b16 v[46:47], v28 offset:37376
    ds_read_b64_tr_b16 v[48:49], v29 offset:36864
    ds_read_b64_tr_b16 v[50:51], v29 offset:37376
    s_waitcnt lgkmcnt(14)
    v_mfma_f32_32x32x16_bf16 v[84:99], v[56:59], v[52:55], v[84:99]
    v_mfma_f32_32x32x16_bf16 v[100:115], v[60:63], v[52:55], v[100:115]
    v_mfma_f32_16x16x32_bf16 v[120:123], v[32:35], v[64:67], v[120:123]
    ds_read_b128 v[52:55], v23 offset:32768
    ds_read_b64_tr_b16 v[56:57], v27 offset:38912
    ds_read_b64_tr_b16 v[58:59], v27 offset:39424
    ds_read_b64_tr_b16 v[60:61], v28 offset:38912
    ds_read_b64_tr_b16 v[62:63], v28 offset:39424
    ds_read_b64_tr_b16 v[64:65], v29 offset:38912
    ds_read_b64_tr_b16 v[66:67], v29 offset:39424
    s_waitcnt lgkmcnt(14)
    v_mfma_f32_32x32x16_bf16 v[84:99], v[72:75], v[68:71], v[84:99]
    v_mfma_f32_32x32x16_bf16 v[100:115], v[76:79], v[68:71], v[100:115]
    v_mfma_f32_16x16x32_bf16 v[120:123], v[32:35], v[80:83], v[120:123]
    s_waitcnt lgkmcnt(7)
    v_mfma_f32_32x32x16_bf16 v[84:99], v[40:43], v[36:39], v[84:99]
    v_mfma_f32_32x32x16_bf16 v[100:115], v[44:47], v[36:39], v[100:115]
    v_mfma_f32_16x16x32_bf16 v[120:123], v[32:35], v[48:51], v[120:123]
    s_waitcnt lgkmcnt(0)
    v_mfma_f32_32x32x16_bf16 v[84:99], v[56:59], v[52:55], v[84:99]
    v_mfma_f32_32x32x16_bf16 v[100:115], v[60:63], v[52:55], v[100:115]
    v_mfma_f32_16x16x32_bf16 v[120:123], v[32:35], v[64:67], v[120:123]
    s_waitcnt vmcnt(2)
    s_and_b32 s40, s29, 1
    s_lshl_b32 s40, s40, 8
    s_lshr_b32 s41, s29, 1
    s_lshl_b32 s41, s41, 7
    s_add_u32 s40, s40, s41
    s_add_u32 s40, s40, 0x24800
    v_lshl_add_u32 v3, v1, 2, s40
    s_mov_b64 exec, 0xffff
    ds_write_b32 v3, v120
    ds_write_b32 v3, v121 offset:64
    s_mov_b64 exec, -1
K1_JOIN:
    s_lshl_b32 s40, s29, 9
    s_add_u32 s40, s40, 0x24000
    v_lshl_add_u32 v3, v9, 4, s40
    s_cmp_eq_u32 s34, 0
    s_cselect_b32 s43, 0x3eb8aa3b, 1.0
    s_lshl_b32 s41, s31, 2
    s_add_u32 s41, s41, s29
    v_mul_f32 v182, s43, v181
    s_waitcnt lgkmcnt(0)
    s_barrier
    s_lshl_b32 s40, s30, 8
    s_add_u32 s40, s40, 0x24800
    v_lshl_add_u32 v4, v10, 4, s40
    ds_read_b128 v[124:127], v4 offset:0
    ds_read_b128 v[128:131], v4 offset:32
    ds_read_b128 v[132:135], v4 offset:64
    ds_read_b128 v[136:139], v4 offset:96
    ds_read_b128 v[140:143], v4 offset:128
    ds_read_b128 v[144:147], v4 offset:160
    ds_read_b128 v[148:151], v4 offset:192
    ds_read_b128 v[152:155], v4 offset:224
    s_cmp_lg_u32 s34, 3
    s_cbranch_scc1 K1_NOST
    v_mul_f32 v187, v182, v182
    v_mov_b32 v186, 0x3f800054
    v_fmamk_f32 v187, v187, 0xb727c5ac, v186
    v_rsq_f32 v187, v187
    s_nop 0
    v_mul_f32 v182, v182, v187
    v_rcp_f32 v194, v182
    v_mul_f32 v190, 0xc0135761, v182
    v_mul_f32 v192, v182, v182
    v_mul_f32 v192, v192, v182
    v_mul_f32 v192, 0xbdd2d3e8, v192
    v_mov_b32 v195, v194
    v_mov_b32 v191, v190
    v_mov_b32 v193, v192
K1_NOST:
    v_sub_f32 v180, 0, v180
    v_mov_b32 v183, v182
    v_mov_b32 v181, v180
    s_waitcnt lgkmcnt(0)
    v_pk_fma_f32 v[84:85], v[124:125], v[180:181], v[84:85]
    v_pk_fma_f32 v[86:87], v[126:127], v[180:181], v[86:87]
    v_pk_fma_f32 v[88:89], v[128:129], v[180:181], v[88:89]
    v_pk_fma_f32 v[90:91], v[130:131], v[180:181], v[90:91]
    v_pk_fma_f32 v[92:93], v[132:133], v[180:181], v[92:93]
    v_pk_fma_f32 v[94:95], v[134:135], v[180:181], v[94:95]
    v_pk_fma_f32 v[96:97], v[136:137], v[180:181], v[96:97]
    v_pk_fma_f32 v[98:99], v[138:139], v[180:181], v[98:99]
    v_pk_fma_f32 v[100:101], v[140:141], v[180:181], v[100:101]
    v_pk_fma_f32 v[102:103], v[142:143], v[180:181], v[102:103]
    v_pk_fma_f32 v[104:105], v[144:145], v[180:181], v[104:105]
    v_pk_fma_f32 v[106:107], v[146:147], v[180:181], v[106:107]
    v_pk_fma_f32 v[108:109], v[148:149], v[180:181], v[108:109]
    v_pk_fma_f32 v[110:111], v[150:151], v[180:181], v[110:111]
    v_pk_fma_f32 v[112:113], v[152:153], v[180:181], v[112:113]
    v_pk_fma_f32 v[114:115], v[154:155], v[180:181], v[114:115]
    v_lshlrev_b32 v5, 4, v1
    s_and_b32 s40, s33, 7
    s_cmp_eq_u32 s34, 3
    s_cbranch_scc1 K1_H
    v_pk_mul_f32 v[84:85], v[84:85], v[182:183]
    v_pk_mul_f32 v[86:87], v[86:87], v[182:183]
    v_pk_mul_f32 v[88:89], v[88:89], v[182:183]
    v_pk_mul_f32 v[90:91], v[90:91], v[182:183]
    v_pk_mul_f32 v[92:93], v[92:93], v[182:183]
    v_pk_mul_f32 v[94:95], v[94:95], v[182:183]
    v_pk_mul_f32 v[96:97], v[96:97], v[182:183]
    v_pk_mul_f32 v[98:99], v[98:99], v[182:183]
    v_pk_mul_f32 v[100:101], v[100:101], v[182:183]
    v_pk_mul_f32 v[102:103], v[102:103], v[182:183]
    v_pk_mul_f32 v[104:105], v[104:105], v[182:183]
    v_pk_mul_f32 v[106:107], v[106:107], v[182:183]
    v_pk_mul_f32 v[108:109], v[108:109], v[182:183]
    v_pk_mul_f32 v[110:111], v[110:111], v[182:183]
    v_pk_mul_f32 v[112:113], v[112:113], v[182:183]
    v_pk_mul_f32 v[114:115], v[114:115], v[182:183]
    v_cvt_pk_bf16_f32 v156, v84, v85
    v_cvt_pk_bf16_f32 v157, v86, v87
    v_cvt_pk_bf16_f32 v158, v88, v89
    v_cvt_pk_bf16_f32 v159, v90, v91
    v_cvt_pk_bf16_f32 v160, v92, v93
    v_cvt_pk_bf16_f32 v161, v94, v95
    v_cvt_pk_bf16_f32 v162, v96, v97
    v_cvt_pk_bf16_f32 v163, v98, v99
    v_cvt_pk_bf16_f32 v164, v100, v101
    v_cvt_pk_bf16_f32 v165, v102, v103
    v_cvt_pk_bf16_f32 v166, v104, v105
    v_cvt_pk_bf16_f32 v167, v106, v107
    v_cvt_pk_bf16_f32 v168, v108, v109
    v_cvt_pk_bf16_f32 v169, v110, v111
    v_cvt_pk_bf16_f32 v170, v112, v113
    v_cvt_pk_bf16_f32 v171, v114, v115
    s_cmp_eq_u32 s34, 0
    s_cbranch_scc1 K1_Q
    s_mov_b32 s44, 0x20000
    s_lshl_b32 s45, s40, 19
    s_lshl_b32 s40, s41, 11
    s_add_u32 s45, s45, s40
    s_add_u32 s45, s45, 0x200000
    s_cmp_eq_u32 s34, 2
    s_cbranch_scc1 K1_V
    v_and_b32 v185, 0x33, v1
    v_bfe_u32 v186, v1, 2, 1
    v_lshl_add_u32 v185, v186, 3, v185
    v_bfe_u32 v186, v1, 3, 1
    v_lshl_add_u32 v185, v186, 2, v185
    v_lshlrev_b32 v185, 4, v185
    s_branch K1_STORE
K1_V:
    s_add_u32 s45, s45, 1024
    s_lshl_b32 s40, s28, 12
    s_add_u32 s40, s40, 0x10000
    v_lshlrev_b32 v186, 5, v9
    v_lshl_add_u32 v186, v10, 4, v186
    v_add_u32 v186, s40, v186
    ds_write_b128 v186, v[156:159] offset:0
    ds_write_b128 v186, v[160:163] offset:1024
    ds_write_b128 v186, v[164:167] offset:2048
    ds_write_b128 v186, v[168:171] offset:3072
    v_bfe_u32 v187, v1, 4, 1
    v_lshlrev_b32 v185, 9, v187
    v_lshl_add_u32 v186, v10, 7, v185
    v_and_b32 v187, 15, v1
    v_lshl_add_u32 v186, v187, 3, v186
    v_add_u32 v186, s40, v186
    v_lshl_add_u32 v185, v10, 8, v185
    v_lshl_add_u32 v185, v187, 4, v185
    s_waitcnt lgkmcnt(0)
    ds_read_b64_tr_b16 v[156:157], v186 offset:0
    ds_read_b64_tr_b16 v[158:159], v186 offset:256
    ds_read_b64_tr_b16 v[160:161], v186 offset:1024
    ds_read_b64_tr_b16 v[162:163], v186 offset:1280
    ds_read_b64_tr_b16 v[164:165], v186 offset:2048
    ds_read_b64_tr_b16 v[166:167], v186 offset:2304
    ds_read_b64_tr_b16 v[168:169], v186 offset:3072
    ds_read_b64_tr_b16 v[170:171], v186 offset:3328
    s_waitcnt lgkmcnt(0)
    s_branch K1_STORE
K1_Q:
    s_mov_b32 s44, 0x10000
    s_lshl_b32 s45, s40, 18
    s_lshl_b32 s40, s41, 10
    s_add_u32 s45, s45, s40
    v_mov_b32 v185, v5
K1_STORE:
    buffer_store_dwordx4 v[156:159], v185, s[16:19], s45 offen sc1
    s_add_u32 s45, s45, s44
    buffer_store_dwordx4 v[160:163], v185, s[16:19], s45 offen sc1
    s_add_u32 s45, s45, s44
    buffer_store_dwordx4 v[164:167], v185, s[16:19], s45 offen sc1
    s_add_u32 s45, s45, s44
    buffer_store_dwordx4 v[168:171], v185, s[16:19], s45 offen sc1
    s_branch K1_PACK
K1_H:
    s_lshl_b32 s45, s40, 12
    s_lshl_b32 s40, s41, 15
    s_add_u32 s45, s45, s40
    s_add_u32 s45, s45, 0x600000
    v_bfe_u32 v185, v1, 4, 1
    v_lshlrev_b32 v185, 14, v185
    v_and_b32 v186, 15, v1
    v_lshl_add_u32 v185, v186, 4, v185
    v_lshl_add_u32 v185, v10, 8, v185
    v_pk_mul_f32 v[172:173], v[84:85], v[84:85]
    v_pk_mul_f32 v[174:175], v[86:87], v[86:87]
    v_pk_mul_f32 v[176:177], v[88:89], v[88:89]
    v_pk_mul_f32 v[178:179], v[90:91], v[90:91]
    v_pk_fma_f32 v[172:173], v[172:173], v[192:193], v[190:191]
    v_pk_fma_f32 v[174:175], v[174:175], v[192:193], v[190:191]
    v_pk_fma_f32 v[176:177], v[176:177], v[192:193], v[190:191]
    v_pk_fma_f32 v[178:179], v[178:179], v[192:193], v[190:191]
    v_pk_mul_f32 v[172:173], v[172:173], v[84:85]
    v_pk_mul_f32 v[174:175], v[174:175], v[86:87]
    v_pk_mul_f32 v[176:177], v[176:177], v[88:89]
    v_pk_mul_f32 v[178:179], v[178:179], v[90:91]
    v_exp_f32 v172, v172
    v_exp_f32 v173, v173
    v_exp_f32 v174, v174
    v_exp_f32 v175, v175
    v_exp_f32 v176, v176
    v_exp_f32 v177, v177
    v_exp_f32 v178, v178
    v_exp_f32 v179, v179
    v_pk_fma_f32 v[172:173], v[172:173], v[194:195], v[194:195]
    v_pk_fma_f32 v[174:175], v[174:175], v[194:195], v[194:195]
    v_pk_fma_f32 v[176:177], v[176:177], v[194:195], v[194:195]
    v_pk_fma_f32 v[178:179], v[178:179], v[194:195], v[194:195]
    v_rcp_f32 v172, v172
    v_rcp_f32 v173, v173
    v_rcp_f32 v174, v174
    v_rcp_f32 v175, v175
    v_rcp_f32 v176, v176
    v_rcp_f32 v177, v177
    v_rcp_f32 v178, v178
    v_rcp_f32 v179, v179
    v_pk_mul_f32 v[84:85], v[84:85], v[172:173]
    v_pk_mul_f32 v[86:87], v[86:87], v[174:175]
    v_pk_mul_f32 v[88:89], v[88:89], v[176:177]
    v_pk_mul_f32 v[90:91], v[90:91], v[178:179]
    v_cvt_pk_bf16_f32 v156, v84, v85
    v_cvt_pk_bf16_f32 v157, v86, v87
    v_cvt_pk_bf16_f32 v158, v88, v89
    v_cvt_pk_bf16_f32 v159, v90, v91
    buffer_store_dwordx4 v[156:159], v5, s[16:19], s45 offen offset:0 sc1
    v_pk_mul_f32 v[172:173], v[92:93], v[92:93]
    v_pk_mul_f32 v[174:175], v[94:95], v[94:95]
    v_pk_mul_f32 v[176:177], v[96:97], v[96:97]
    v_pk_mul_f32 v[178:179], v[98:99], v[98:99]
    v_pk_fma_f32 v[172:173], v[172:173], v[192:193], v[190:191]
    v_pk_fma_f32 v[174:175], v[174:175], v[192:193], v[190:191]
    v_pk_fma_f32 v[176:177], v[176:177], v[192:193], v[190:191]
    v_pk_fma_f32 v[178:179], v[178:179], v[192:193], v[190:191]
    v_pk_mul_f32 v[172:173], v[172:173], v[92:93]
    v_pk_mul_f32 v[174:175], v[174:175], v[94:95]
    v_pk_mul_f32 v[176:177], v[176:177], v[96:97]
    v_pk_mul_f32 v[178:179], v[178:179], v[98:99]
    v_exp_f32 v172, v172
    v_exp_f32 v173, v173
    v_exp_f32 v174, v174
    v_exp_f32 v175, v175
    v_exp_f32 v176, v176
    v_exp_f32 v177, v177
    v_exp_f32 v178, v178
    v_exp_f32 v179, v179
    v_pk_fma_f32 v[172:173], v[172:173], v[194:195], v[194:195]
    v_pk_fma_f32 v[174:175], v[174:175], v[194:195], v[194:195]
    v_pk_fma_f32 v[176:177], v[176:177], v[194:195], v[194:195]
    v_pk_fma_f32 v[178:179], v[178:179], v[194:195], v[194:195]
    v_rcp_f32 v172, v172
    v_rcp_f32 v173, v173
    v_rcp_f32 v174, v174
    v_rcp_f32 v175, v175
    v_rcp_f32 v176, v176
    v_rcp_f32 v177, v177
    v_rcp_f32 v178, v178
    v_rcp_f32 v179, v179
    v_pk_mul_f32 v[92:93], v[92:93], v[172:173]
    v_pk_mul_f32 v[94:95], v[94:95], v[174:175]
    v_pk_mul_f32 v[96:97], v[96:97], v[176:177]
    v_pk_mul_f32 v[98:99], v[98:99], v[178:179]
    v_cvt_pk_bf16_f32 v160, v92, v93
    v_cvt_pk_bf16_f32 v161, v94, v95
    v_cvt_pk_bf16_f32 v162, v96, v97
    v_cvt_pk_bf16_f32 v163, v98, v99
    buffer_store_dwordx4 v[160:163], v5, s[16:19], s45 offen offset:1024 sc1
    v_pk_mul_f32 v[172:173], v[100:101], v[100:101]
    v_pk_mul_f32 v[174:175], v[102:103], v[102:103]
    v_pk_mul_f32 v[176:177], v[104:105], v[104:105]
    v_pk_mul_f32 v[178:179], v[106:107], v[106:107]
    v_pk_fma_f32 v[172:173], v[172:173], v[192:193], v[190:191]
    v_pk_fma_f32 v[174:175], v[174:175], v[192:193], v[190:191]
    v_pk_fma_f32 v[176:177], v[176:177], v[192:193], v[190:191]
    v_pk_fma_f32 v[178:179], v[178:179], v[192:193], v[190:191]
    v_pk_mul_f32 v[172:173], v[172:173], v[100:101]
    v_pk_mul_f32 v[174:175], v[174:175], v[102:103]
    v_pk_mul_f32 v[176:177], v[176:177], v[104:105]
    v_pk_mul_f32 v[178:179], v[178:179], v[106:107]
    v_exp_f32 v172, v172
    v_exp_f32 v173, v173
    v_exp_f32 v174, v174
    v_exp_f32 v175, v175
    v_exp_f32 v176, v176
    v_exp_f32 v177, v177
    v_exp_f32 v178, v178
    v_exp_f32 v179, v179
    v_pk_fma_f32 v[172:173], v[172:173], v[194:195], v[194:195]
    v_pk_fma_f32 v[174:175], v[174:175], v[194:195], v[194:195]
    v_pk_fma_f32 v[176:177], v[176:177], v[194:195], v[194:195]
    v_pk_fma_f32 v[178:179], v[178:179], v[194:195], v[194:195]
    v_rcp_f32 v172, v172
    v_rcp_f32 v173, v173
    v_rcp_f32 v174, v174
    v_rcp_f32 v175, v175
    v_rcp_f32 v176, v176
    v_rcp_f32 v177, v177
    v_rcp_f32 v178, v178
    v_rcp_f32 v179, v179
    v_pk_mul_f32 v[100:101], v[100:101], v[172:173]
    v_pk_mul_f32 v[102:103], v[102:103], v[174:175]
    v_pk_mul_f32 v[104:105], v[104:105], v[176:177]
    v_pk_mul_f32 v[106:107], v[106:107], v[178:179]
    v_cvt_pk_bf16_f32 v164, v100, v101
    v_cvt_pk_bf16_f32 v165, v102, v103
    v_cvt_pk_bf16_f32 v166, v104, v105
    v_cvt_pk_bf16_f32 v167, v106, v107
    buffer_store_dwordx4 v[164:167], v5, s[16:19], s45 offen offset:2048 sc1
    v_pk_mul_f32 v[172:173], v[108:109], v[108:109]
    v_pk_mul_f32 v[174:175], v[110:111], v[110:111]
    v_pk_mul_f32 v[176:177], v[112:113], v[112:113]
    v_pk_mul_f32 v[178:179], v[114:115], v[114:115]
    v_pk_fma_f32 v[172:173], v[172:173], v[192:193], v[190:191]
    v_pk_fma_f32 v[174:175], v[174:175], v[192:193], v[190:191]
    v_pk_fma_f32 v[176:177], v[176:177], v[192:193], v[190:191]
    v_pk_fma_f32 v[178:179], v[178:179], v[192:193], v[190:191]
    v_pk_mul_f32 v[172:173], v[172:173], v[108:109]
    v_pk_mul_f32 v[174:175], v[174:175], v[110:111]
    v_pk_mul_f32 v[176:177], v[176:177], v[112:113]
    v_pk_mul_f32 v[178:179], v[178:179], v[114:115]
    v_exp_f32 v172, v172
    v_exp_f32 v173, v173
    v_exp_f32 v174, v174
    v_exp_f32 v175, v175
    v_exp_f32 v176, v176
    v_exp_f32 v177, v177
    v_exp_f32 v178, v178
    v_exp_f32 v179, v179
    v_pk_fma_f32 v[172:173], v[172:173], v[194:195], v[194:195]
    v_pk_fma_f32 v[174:175], v[174:175], v[194:195], v[194:195]
    v_pk_fma_f32 v[176:177], v[176:177], v[194:195], v[194:195]
    v_pk_fma_f32 v[178:179], v[178:179], v[194:195], v[194:195]
    v_rcp_f32 v172, v172
    v_rcp_f32 v173, v173
    v_rcp_f32 v174, v174
    v_rcp_f32 v175, v175
    v_rcp_f32 v176, v176
    v_rcp_f32 v177, v177
    v_rcp_f32 v178, v178
    v_rcp_f32 v179, v179
    v_pk_mul_f32 v[108:109], v[108:109], v[172:173]
    v_pk_mul_f32 v[110:111], v[110:111], v[174:175]
    v_pk_mul_f32 v[112:113], v[112:113], v[176:177]
    v_pk_mul_f32 v[114:115], v[114:115], v[178:179]
    v_cvt_pk_bf16_f32 v168, v108, v109
    v_cvt_pk_bf16_f32 v169, v110, v111
    v_cvt_pk_bf16_f32 v170, v112, v113
    v_cvt_pk_bf16_f32 v171, v114, v115
    buffer_store_dwordx4 v[168:171], v5, s[16:19], s45 offen offset:3072 sc1
K1_PACK:
    s_lshl_b32 s40, s28, 11
    s_add_u32 s40, s40, 0x20000
    v_add_u32 v2, s40, v5
    s_waitcnt vmcnt(4)
    ds_write_b128 v2, v[196:199]
    ds_write_b128 v2, v[200:203] offset:1024
    s_lshr_b32 s40, 1024, s5
    v_add_u32 v2, s40, v12
    v_xor_b32 v3, 64, v12
    v_xor_b32 v4, 64, v2
    s_waitcnt lgkmcnt(0)
    ds_read_b64_tr_b16 v[196:197], v12
    ds_read_b64_tr_b16 v[198:199], v2
    ds_read_b64_tr_b16 v[200:201], v3
    ds_read_b64_tr_b16 v[202:203], v4
    s_waitcnt lgkmcnt(0)
    s_mov_b64 exec, 1
    s_lshl_b32 s40, s33, 2
    s_add_u32 s40, s40, 272
    s_add_u32 s41, s31, 56
    s_cmp_eq_u32 s34, 3
    s_cselect_b32 s40, s41, s40
    s_lshl_b32 s40, s40, 8
    s_add_u32 s40, s40, 0x1b00000
    s_lshl_b32 s41, s30, 2
    s_add_u32 s41, s41, 0x27f00
    v_mov_b32 v2, s41
    v_mov_b32 v3, 1
    s_waitcnt vmcnt(0)
    ds_add_rtn_u32 v4, v2, v3
    s_waitcnt lgkmcnt(0)
    v_cmp_ne_u32 vcc, 3, v4
    s_cbranch_vccnz K1_NOSIG
    s_cmp_eq_u32 s34, 3
    s_cselect_b32 exec_lo, 1, 15
    v_lshlrev_b32 v186, 8, v1
    v_mov_b32 v3, 1
    buffer_atomic_add v3, v186, s[16:19], s40 offen sc1
K1_NOSIG:
    s_mov_b64 exec, -1
    buffer_store_dwordx4 v[196:199], v5, s[16:19], s3 offen sc1
    buffer_store_dwordx4 v[200:203], v5, s[16:19], s3 offen offset:1024 sc1
    s_cmp_ge_u32 s101, 88
    s_cbranch_scc1 K1_NOCS3
    v_mfma_f32_16x16x32_bf16 v[172:175], v[32:35], v[196:199], 0
    v_mfma_f32_16x16x32_bf16 v[176:179], v[32:35], v[200:203], 0
    s_lshl_b32 s40, s28, 8
    s_add_u32 s40, s40, 0x24c00
    v_lshl_add_u32 v2, v1, 2, s40
    s_mov_b64 exec, 0xffff
    s_nop 2
    ds_write_b32 v2, v172
    ds_write_b32 v2, v173 offset:64
    ds_write_b32 v2, v176 offset:128
    ds_write_b32 v2, v177 offset:192
    s_mov_b64 exec, -1
K1_NOCS3:
    v_mov_b32 v2, 0x27f08
    v_mov_b32 v3, 1
    s_mov_b64 exec, 1
    s_waitcnt vmcnt(0) lgkmcnt(0)
    ds_add_rtn_u32 v4, v2, v3
    s_waitcnt lgkmcnt(0)
    v_cmp_ne_u32 vcc, 7, v4
    s_mov_b64 exec, -1
    s_cbranch_vccnz K1_FIN
    s_cmp_ge_u32 s101, 88
    s_cbranch_scc1 K1_JSIG
    v_lshlrev_b32 v2, 2, v1
    v_add_u32 v4, 0x24c00, v2
    ds_read_b32 v172, v4 offset:0
    ds_read_b32 v173, v4 offset:256
    ds_read_b32 v174, v4 offset:512
    ds_read_b32 v175, v4 offset:768
    ds_read_b32 v176, v4 offset:1024
    ds_read_b32 v177, v4 offset:1280
    ds_read_b32 v178, v4 offset:1536
    ds_read_b32 v179, v4 offset:1792
    s_mul_i32 s40, s60, 6144
    s_lshl_b32 s41, s61, 8
    s_add_u32 s40, s40, s41
    s_add_u32 s40, s40, 0x1668000
    s_waitcnt lgkmcnt(0)
    v_add_f32 v172, v172, v173
    v_add_f32 v172, v172, v174
    v_add_f32 v172, v172, v175
    v_add_f32 v172, v172, v176
    v_add_f32 v172, v172, v177
    v_add_f32 v172, v172, v178
    v_add_f32 v172, v172, v179
    buffer_store_dword v172, v2, s[16:19], s40 offen sc1
    s_waitcnt vmcnt(0)
K1_JSIG:
    v_mov_b32 v2, 0x27f08
    v_mov_b32 v4, 9
    ds_write_b32 v2, v4
    s_cmp_ge_u32 s101, 240
    s_cbranch_scc1 K1_FIN
    s_add_u32 s40, s54, s61
    s_lshl_b32 s40, s40, 8
    s_add_u32 s40, s40, 0x1b00000
    v_mov_b32 v2, 0
    s_mov_b64 exec, 1
    buffer_atomic_add v3, v2, s[16:19], s40 offen sc1
    s_mov_b64 exec, -1
K1_FIN:
    s_load_dwordx2 s[26:27], s[0:1], 80
    s_load_dwordx2 s[16:17], s[0:1], 0
    s_load_dwordx2 s[18:19], s[0:1], 64
    v_lshrrev_b32 v2, 6, v0
    v_and_b32 v1, 63, v0
    v_readfirstlane_b32 s28, v2
    v_mov_b32 v13, 0x7e800000
    s_cmp_ge_u32 s28, 4
    s_cbranch_scc1 K2_CHAIN
    s_and_b32 s31, s2, 7
    s_xor_b32 s31, s31, 1
    s_lshl_b32 s29, s31, 2
    s_bfe_u32 s31, s2, 0x20003
    s_add_u32 s29, s29, s31
    s_lshr_b32 s30, s2, 5
    v_lshlrev_b32 v3, 4, v1
    s_lshl_b32 s31, s29, 17
    s_add_u32 s31, s31, 0x200000
    s_lshl_b32 s33, s28, 11
    s_lshl_b32 s32, s30, 14
    s_add_u32 s33, s33, s32
    s_mul_i32 s34, s28, 2080
    s_waitcnt lgkmcnt(0)
    s_add_u32 s8, s26, s31
    s_addc_u32 s9, s27, 0
    s_mov_b32 s10, 0x20000
    s_mov_b32 s11, 0x20000
    s_mov_b32 s12, s26
    s_mov_b32 s13, s27
    s_mov_b32 s14, 0x1c00000
    s_mov_b32 s15, 0x20000
    v_mov_b32 v2, 0xdddddddd
    v_and_b32 v10, 15, v1
    v_lshrrev_b32 v11, 5, v1
    v_lshlrev_b32 v4, 4, v10
    v_lshl_add_u32 v4, v11, 8, v4
    v_add_u32 v4, 1024, v4
    v_add_u32 v5, 512, v4
    v_and_b32 v7, 11, v1
    v_cmp_eq_u32 vcc, 0, v7
    v_mov_b32 v6, 2048
    v_mov_b32 v9, 2064
    v_cndmask_b32 v9, v9, v6, vcc
    v_and_b32 v7, 16, v1
    v_cmp_ne_u32 vcc, 0, v7
    v_mov_b32 v140, 0
    v_mov_b32 v141, 0
    v_cndmask_b32 v4, v4, v9, vcc
    v_cndmask_b32 v5, v5, v9, vcc
    v_mov_b32 v142, 0
    v_mov_b32 v143, 0
    v_mul_u32_u24 v10, 2080, v10
    v_mov_b32 v128, 0x3f803f80
    v_mov_b32 v129, 0x3f803f80
    v_mov_b32 v130, 0x3f803f80
    v_mov_b32 v131, 0x3f803f80
    ds_write_b128 v10, v[128:131] offset:2048
    ds_write_b128 v10, v[140:143] offset:2064
    s_lshl_b32 s31, s28, 8
    v_lshl_add_u32 v6, v1, 2, s31
    v_and_b32 v7, 3, v1
    v_lshlrev_b32 v7, 8, v7
    v_lshl_add_u32 v7, v1, 2, v7
    v_mov_b32 v8, 1
    v_mov_b32 v48, 0
    v_mov_b32 v64, 0
    v_mov_b32 v49, 0
    v_mov_b32 v65, 0
    v_mov_b32 v50, 0
    v_mov_b32 v66, 0
    v_mov_b32 v51, 0
    v_mov_b32 v67, 0
    v_mov_b32 v52, 0
    v_mov_b32 v68, 0
    v_mov_b32 v53, 0
    v_mov_b32 v69, 0
    v_mov_b32 v54, 0
    v_mov_b32 v70, 0
    v_mov_b32 v55, 0
    v_mov_b32 v71, 0
    v_mov_b32 v56, 0
    v_mov_b32 v72, 0
    s_and_b32 s31, s29, 0xfc
    s_and_b32 s32, s29, 3
    s_add_u32 s31, s31, s32
    s_add_u32 s31, s31, 272
    v_lshl_add_u32 v10, v1, 5, s31
    v_lshlrev_b32 v10, 8, v10
    s_mov_b32 s32, 0x1b00000
    s_mov_b32 s31, 400000
    s_cmp_lg_u32 s28, 0
    s_cbranch_scc1 AT_GOW
    v_mov_b32 v9, 0
    v_mov_b32 v16, 0
    s_mov_b64 exec, 7
    buffer_atomic_umax v9, v10, s[12:15], s32 offen sc0 sc1
    s_sleep 5
AT_P:
    buffer_atomic_umax v16, v10, s[12:15], s32 offen sc0 sc1
    s_sub_u32 s31, s31, 1
    s_cmp_eq_u32 s31, 0
    s_cbranch_scc1 AT_PX
    s_waitcnt vmcnt(1)
    v_cmp_gt_u32 vcc, 16, v9
    s_cbranch_vccz AT_PX
    buffer_atomic_umax v9, v10, s[12:15], s32 offen sc0 sc1
    s_waitcnt vmcnt(1)
    v_cmp_gt_u32 vcc, 16, v16
    s_cbranch_vccz AT_PX
    s_branch AT_P
AT_PX:
    s_mov_b64 exec, -1
    v_mov_b32 v11, 0
    ds_write_b32 v11, v8 offset:35336
    s_branch AT_GO
AT_GOW:
    v_mov_b32 v11, 0
    ds_read_b32 v9, v11 offset:35336
    s_sub_u32 s31, s31, 1
    s_cmp_eq_u32 s31, 0
    s_cbranch_scc1 AT_GO
    s_waitcnt lgkmcnt(0)
    v_cmp_eq_u32 vcc, 0, v9
    s_cbranch_vccnz AT_GOW
AT_GO:
    s_add_u32 m0, s34, 0
    s_nop 0
    buffer_load_dwordx4 v3, s[8:11], s33 offen sc1 lds
    buffer_load_dwordx4 v3, s[8:11], s33 offen offset:1024 sc1 lds
    s_add_u32 s33, s33, 8192
    s_and_b32 s33, s33, 0x1ffff
    s_lshl_b32 s31, s29, 16
    s_lshl_b32 s32, s30, 13
    s_add_u32 s31, s31, s32
    s_lshl_b32 s32, s28, 11
    s_add_u32 s31, s31, s32
    buffer_load_dwordx4 v[112:115], v3, s[12:15], s31 offen sc1
    buffer_load_dwordx4 v[116:119], v3, s[12:15], s31 offen offset:1024 sc1
    s_add_u32 m0, s34, 8320
    s_nop 0
    buffer_load_dwordx4 v3, s[8:11], s33 offen sc1 lds
    buffer_load_dwordx4 v3, s[8:11], s33 offen offset:1024 sc1 lds
    s_add_u32 s33, s33, 8192
    s_and_b32 s33, s33, 0x1ffff
    s_add_u32 m0, s34, 16640
    s_nop 0
    buffer_load_dwordx4 v3, s[8:11], s33 offen sc1 lds
    buffer_load_dwordx4 v3, s[8:11], s33 offen offset:1024 sc1 lds
    s_add_u32 s33, s33, 8192
    s_and_b32 s33, s33, 0x1ffff
    s_lshl_b32 s53, s30, 2
    s_add_u32 s53, s53, s28
    s_lshr_b32 s52, s53, 1
    s_lshl_b32 s52, s52, 10
    s_add_u32 s52, s52, 0x1b18000
    s_lshl_b32 s53, s53, 2
    s_lshr_b32 s31, s29, 3
    s_add_u32 s53, s53, s31
    s_lshl_b32 s53, s53, 8
    s_add_u32 s53, s53, 0x1b08000
    s_mov_b32 s54, 0x40000000
    v_bfe_u32 v146, v1, 4, 1
    v_lshlrev_b32 v146, 14, v146
    v_and_b32 v12, 15, v1
    v_lshl_add_u32 v146, v12, 4, v146
    v_lshrrev_b32 v12, 5, v1
    v_lshl_add_u32 v146, v12, 8, v146
    v_mov_b32 v12, 0
    v_mov_b32 v14, 0
    v_mov_b32 v15, 1
    s_mov_b32 s35, 2
    s_mov_b32 s36, 3
    s_mov_b32 s31, 400000
    s_waitcnt vmcnt(4)
    ds_write_b32 v6, v8 offset:33280
AT_W0:
    ds_read_b32 v9, v7 offset:33280
    s_sub_u32 s31, s31, 1
    s_cmp_eq_u32 s31, 0
    s_cbranch_scc1 AT_X0
    s_waitcnt lgkmcnt(0)
    v_cmp_gt_u32 vcc, 1, v9
    s_cbranch_vccnz AT_W0
AT_X0:
    ds_read_b128 v[120:123], v3
    ds_read_b128 v[128:131], v4
    ds_read_b128 v[132:135], v5
    s_waitcnt lgkmcnt(2)
    v_mfma_f32_32x32x16_bf16 v[16:31], v[120:123], v[112:115], 0
    v_mfma_f32_32x32x16_bf16 v[32:47], v[120:123], v[116:119], 0
    s_nop 10
    v_max3_f32 v80, v16, v17, v18
    v_max3_f32 v80, v80, v19, v20
    v_max3_f32 v80, v80, v21, v22
    v_max3_f32 v80, v80, v23, v24
    v_max3_f32 v80, v80, v25, v26
    v_max3_f32 v80, v80, v27, v28
    v_max3_f32 v80, v80, v29, v30
    v_max_f32 v80, v80, v31
    v_mov_b32 v10, v80
    s_nop 1
    v_permlane32_swap_b32 v80, v10
    v_max_f32 v10, v80, v10
    v_sub_f32 v80, 0, v10
    v_sub_f32 v81, 0, v10
    v_sub_f32 v82, 0, v10
    v_sub_f32 v83, 0, v10
    v_sub_f32 v84, 0, v10
    v_sub_f32 v85, 0, v10
    v_sub_f32 v86, 0, v10
    v_sub_f32 v87, 0, v10
    v_sub_f32 v88, 0, v10
    v_sub_f32 v89, 0, v10
    v_sub_f32 v90, 0, v10
    v_sub_f32 v91, 0, v10
    v_sub_f32 v92, 0, v10
    v_sub_f32 v93, 0, v10
    v_sub_f32 v94, 0, v10
    v_sub_f32 v95, 0, v10
    s_nop 1
    v_mfma_f32_32x32x16_bf16 v[16:31], v[120:123], v[112:115], v[80:95]
    v_max3_f32 v96, v32, v33, v34
    v_max3_f32 v96, v96, v35, v36
    v_max3_f32 v96, v96, v37, v38
    v_max3_f32 v96, v96, v39, v40
    v_max3_f32 v96, v96, v41, v42
    v_max3_f32 v96, v96, v43, v44
    v_max3_f32 v96, v96, v45, v46
    v_max_f32 v96, v96, v47
    v_mov_b32 v11, v96
    s_nop 1
    v_permlane32_swap_b32 v96, v11
    v_max_f32 v11, v96, v11
    v_sub_f32 v96, 0, v11
    v_sub_f32 v97, 0, v11
    v_sub_f32 v98, 0, v11
    v_sub_f32 v99, 0, v11
    v_sub_f32 v100, 0, v11
    v_sub_f32 v101, 0, v11
    v_sub_f32 v102, 0, v11
    v_sub_f32 v103, 0, v11
    v_sub_f32 v104, 0, v11
    v_sub_f32 v105, 0, v11
    v_sub_f32 v106, 0, v11
    v_sub_f32 v107, 0, v11
    v_sub_f32 v108, 0, v11
    v_sub_f32 v109, 0, v11
    v_sub_f32 v110, 0, v11
    v_sub_f32 v111, 0, v11
    v_mov_b32 v40, 0
    v_mov_b32 v41, 0
    v_mov_b32 v42, 0
    v_mov_b32 v43, 0
    v_mov_b32 v44, 0
    v_mov_b32 v45, 0
    v_mov_b32 v46, 0
    v_mov_b32 v47, 0
.p2align 6
AT_LOOP:
    v_exp_f32 v16, v16
    v_exp_f32 v17, v17
    v_smfmac_f32_32x32x32_bf16 v[64:79], v[140:143], v[40:47], v2
    s_waitcnt lgkmcnt(0)
    ds_read_b128 v[124:127], v3 offset:2080
    v_exp_f32 v18, v18
    v_exp_f32 v19, v19
    v_exp_f32 v20, v20
    v_exp_f32 v21, v21
    v_exp_f32 v22, v22
    v_mfma_f32_32x32x16_bf16 v[32:47], v[120:123], v[116:119], v[96:111]
    ds_read_b128 v[136:139], v4 offset:2080
    v_exp_f32 v23, v23
    v_exp_f32 v24, v24
    v_exp_f32 v25, v25
    v_exp_f32 v26, v26
    v_exp_f32 v27, v27
    v_exp_f32 v28, v28
    v_smfmac_f32_32x32x32_bf16 v[48:63], v[128:131], v[16:23], v2
    ds_read_b128 v[140:143], v5 offset:2080
    v_exp_f32 v29, v29
    v_exp_f32 v30, v30
    v_exp_f32 v31, v31
    v_exp_f32 v32, v32
    v_exp_f32 v33, v33
    v_smfmac_f32_32x32x32_bf16 v[48:63], v[132:135], v[24:31], v2
    s_waitcnt lgkmcnt(2)
    v_exp_f32 v34, v34
    v_exp_f32 v35, v35
    v_exp_f32 v36, v36
    v_exp_f32 v37, v37
    v_exp_f32 v38, v38
    v_mfma_f32_32x32x16_bf16 v[16:31], v[124:127], v[112:115], v[80:95]
    v_add_u32 v8, 1, v8
    v_exp_f32 v39, v39
    v_exp_f32 v40, v40
    v_exp_f32 v41, v41
    v_exp_f32 v42, v42
    v_exp_f32 v43, v43
    v_exp_f32 v44, v44
    v_smfmac_f32_32x32x32_bf16 v[64:79], v[128:131], v[32:39], v2
    s_waitcnt vmcnt(2)
    ds_write_b32 v6, v8 offset:33280
    v_exp_f32 v45, v45
    v_exp_f32 v46, v46
    v_exp_f32 v47, v47
    v_exp_f32 v16, v16
    v_exp_f32 v17, v17
    v_smfmac_f32_32x32x32_bf16 v[64:79], v[132:135], v[40:47], v2
    s_waitcnt lgkmcnt(0)
    ds_read_b128 v[120:123], v3 offset:4160
    v_exp_f32 v18, v18
    v_exp_f32 v19, v19
    v_exp_f32 v20, v20
    v_exp_f32 v21, v21
    v_exp_f32 v22, v22
    v_mfma_f32_32x32x16_bf16 v[32:47], v[124:127], v[116:119], v[96:111]
    ds_read_b128 v[128:131], v4 offset:4160
    v_exp_f32 v23, v23
    v_exp_f32 v24, v24
    v_exp_f32 v25, v25
    v_exp_f32 v26, v26
    v_exp_f32 v27, v27
    v_exp_f32 v28, v28
    v_smfmac_f32_32x32x32_bf16 v[48:63], v[136:139], v[16:23], v2
    ds_read_b128 v[132:135], v5 offset:4160
    v_exp_f32 v29, v29
    v_exp_f32 v30, v30
    v_exp_f32 v31, v31
    v_exp_f32 v32, v32
    v_exp_f32 v33, v33
    v_smfmac_f32_32x32x32_bf16 v[48:63], v[140:143], v[24:31], v2
    s_waitcnt lgkmcnt(2)
    v_exp_f32 v34, v34
    v_exp_f32 v35, v35
    v_exp_f32 v36, v36
    v_exp_f32 v37, v37
    v_exp_f32 v38, v38
    v_mfma_f32_32x32x16_bf16 v[16:31], v[120:123], v[112:115], v[80:95]
    v_exp_f32 v39, v39
    v_exp_f32 v40, v40
    v_exp_f32 v41, v41
    v_exp_f32 v42, v42
    v_exp_f32 v43, v43
    v_exp_f32 v44, v44
    v_smfmac_f32_32x32x32_bf16 v[64:79], v[136:139], v[32:39], v2
    v_exp_f32 v45, v45
    v_exp_f32 v46, v46
    v_exp_f32 v47, v47
    s_nop 1
    v_exp_f32 v16, v16
    v_exp_f32 v17, v17
    v_smfmac_f32_32x32x32_bf16 v[64:79], v[140:143], v[40:47], v2
    s_waitcnt lgkmcnt(0)
    ds_read_b128 v[124:127], v3 offset:6240
    v_exp_f32 v18, v18
    v_exp_f32 v19, v19
    v_exp_f32 v20, v20
    v_exp_f32 v21, v21
    v_exp_f32 v22, v22
    v_mfma_f32_32x32x16_bf16 v[32:47], v[120:123], v[116:119], v[96:111]
    ds_read_b128 v[136:139], v4 offset:6240
    v_exp_f32 v23, v23
    v_exp_f32 v24, v24
    v_exp_f32 v25, v25
    v_exp_f32 v26, v26
    v_exp_f32 v27, v27
    v_exp_f32 v28, v28
    v_smfmac_f32_32x32x32_bf16 v[48:63], v[128:131], v[16:23], v2
    ds_read_b128 v[140:143], v5 offset:6240
    v_exp_f32 v29, v29
    v_exp_f32 v30, v30
    v_exp_f32 v31, v31
    v_exp_f32 v32, v32
    v_exp_f32 v33, v33
    v_smfmac_f32_32x32x32_bf16 v[48:63], v[132:135], v[24:31], v2
    s_waitcnt lgkmcnt(2)
    v_exp_f32 v34, v34
    v_exp_f32 v35, v35
    v_exp_f32 v36, v36
    v_exp_f32 v37, v37
    v_exp_f32 v38, v38
    v_mfma_f32_32x32x16_bf16 v[16:31], v[124:127], v[112:115], v[80:95]
    v_exp_f32 v39, v39
    v_exp_f32 v40, v40
    v_exp_f32 v41, v41
    v_exp_f32 v42, v42
    v_exp_f32 v43, v43
    v_exp_f32 v44, v44
    v_smfmac_f32_32x32x32_bf16 v[64:79], v[128:131], v[32:39], v2
    ds_read_b32 v9, v7 offset:33280
    v_exp_f32 v45, v45
    v_exp_f32 v46, v46
    v_exp_f32 v47, v47
    s_nop 0
    v_exp_f32 v16, v16
    v_exp_f32 v17, v17
    v_smfmac_f32_32x32x32_bf16 v[64:79], v[132:135], v[40:47], v2
    s_waitcnt lgkmcnt(0)
    v_cmp_gt_u32 vcc, s35, v9
    s_cbranch_vccnz AT_SPIN3
AT_BACK3:
    ds_read_b128 v[120:123], v3 offset:8320
    v_exp_f32 v18, v18
    v_exp_f32 v19, v19
    v_exp_f32 v20, v20
    v_exp_f32 v21, v21
    v_exp_f32 v22, v22
    v_mfma_f32_32x32x16_bf16 v[32:47], v[124:127], v[116:119], v[96:111]
    ds_read_b128 v[128:131], v4 offset:8320
    v_exp_f32 v23, v23
    v_exp_f32 v24, v24
    v_exp_f32 v25, v25
    v_exp_f32 v26, v26
    v_exp_f32 v27, v27
    v_exp_f32 v28, v28
    v_smfmac_f32_32x32x32_bf16 v[48:63], v[136:139], v[16:23], v2
    ds_read_b128 v[132:135], v5 offset:8320
    s_add_u32 m0, s34, 24960
    s_add_u32 s35, s35, 1
    v_exp_f32 v29, v29
    v_exp_f32 v30, v30
    v_exp_f32 v31, v31
    v_exp_f32 v32, v32
    v_exp_f32 v33, v33
    v_smfmac_f32_32x32x32_bf16 v[48:63], v[140:143], v[24:31], v2
    s_waitcnt lgkmcnt(2)
    buffer_load_dwordx4 v3, s[8:11], s33 offen sc1 lds
    v_exp_f32 v34, v34
    v_exp_f32 v35, v35
    v_exp_f32 v36, v36
    v_exp_f32 v37, v37
    v_exp_f32 v38, v38
    v_mfma_f32_32x32x16_bf16 v[16:31], v[120:123], v[112:115], v[80:95]
    v_exp_f32 v39, v39
    v_exp_f32 v40, v40
    v_exp_f32 v41, v41
    v_exp_f32 v42, v42
    v_exp_f32 v43, v43
    v_exp_f32 v44, v44
    v_smfmac_f32_32x32x32_bf16 v[64:79], v[136:139], v[32:39], v2
    buffer_load_dwordx4 v3, s[8:11], s33 offen offset:1024 sc1 lds
    s_add_u32 s33, s33, 8192
    s_and_b32 s33, s33, 0x1ffff
    v_exp_f32 v45, v45
    v_exp_f32 v46, v46
    v_exp_f32 v47, v47
    v_exp_f32 v16, v16
    v_exp_f32 v17, v17
    v_smfmac_f32_32x32x32_bf16 v[64:79], v[140:143], v[40:47], v2
    s_waitcnt lgkmcnt(0)
    ds_read_b128 v[124:127], v3 offset:10400
    v_exp_f32 v18, v18
    v_exp_f32 v19, v19
    v_exp_f32 v20, v20
    v_exp_f32 v21, v21
    v_exp_f32 v22, v22
    v_mfma_f32_32x32x16_bf16 v[32:47], v[120:123], v[116:119], v[96:111]
    ds_read_b128 v[136:139], v4 offset:10400
    v_exp_f32 v23, v23
    v_exp_f32 v24, v24
    v_exp_f32 v25, v25
    v_exp_f32 v26, v26
    v_exp_f32 v27, v27
    v_exp_f32 v28, v28
    v_smfmac_f32_32x32x32_bf16 v[48:63], v[128:131], v[16:23], v2
    ds_read_b128 v[140:143], v5 offset:10400
    v_exp_f32 v29, v29
    v_exp_f32 v30, v30
    v_exp_f32 v31, v31
    v_exp_f32 v32, v32
    v_exp_f32 v33, v33
    v_smfmac_f32_32x32x32_bf16 v[48:63], v[132:135], v[24:31], v2
    s_waitcnt lgkmcnt(2)
    v_exp_f32 v34, v34
    v_exp_f32 v35, v35
    v_exp_f32 v36, v36
    v_exp_f32 v37, v37
    v_exp_f32 v38, v38
    v_mfma_f32_32x32x16_bf16 v[16:31], v[124:127], v[112:115], v[80:95]
    v_add_u32 v8, 1, v8
    v_exp_f32 v39, v39
    v_exp_f32 v40, v40
    v_exp_f32 v41, v41
    v_exp_f32 v42, v42
    v_exp_f32 v43, v43
    v_exp_f32 v44, v44
    v_smfmac_f32_32x32x32_bf16 v[64:79], v[128:131], v[32:39], v2
    s_waitcnt vmcnt(2)
    ds_write_b32 v6, v8 offset:33280
    v_exp_f32 v45, v45
    v_exp_f32 v46, v46
    v_exp_f32 v47, v47
    v_exp_f32 v16, v16
    v_exp_f32 v17, v17
    v_smfmac_f32_32x32x32_bf16 v[64:79], v[132:135], v[40:47], v2
    s_waitcnt lgkmcnt(0)
    ds_read_b128 v[120:123], v3 offset:12480
    v_exp_f32 v18, v18
    v_exp_f32 v19, v19
    v_exp_f32 v20, v20
    v_exp_f32 v21, v21
    v_exp_f32 v22, v22
    v_mfma_f32_32x32x16_bf16 v[32:47], v[124:127], v[116:119], v[96:111]
    ds_read_b128 v[128:131], v4 offset:12480
    v_exp_f32 v23, v23
    v_exp_f32 v24, v24
    v_exp_f32 v25, v25
    v_exp_f32 v26, v26
    v_exp_f32 v27, v27
    v_exp_f32 v28, v28
    v_smfmac_f32_32x32x32_bf16 v[48:63], v[136:139], v[16:23], v2
    ds_read_b128 v[132:135], v5 offset:12480
    v_exp_f32 v29, v29
    v_exp_f32 v30, v30
    v_exp_f32 v31, v31
    v_exp_f32 v32, v32
    v_exp_f32 v33, v33
    v_smfmac_f32_32x32x32_bf16 v[48:63], v[140:143], v[24:31], v2
    s_waitcnt lgkmcnt(2)
    v_exp_f32 v34, v34
    v_exp_f32 v35, v35
    v_exp_f32 v36, v36
    v_exp_f32 v37, v37
    v_exp_f32 v38, v38
    v_mfma_f32_32x32x16_bf16 v[16:31], v[120:123], v[112:115], v[80:95]
    v_exp_f32 v39, v39
    v_exp_f32 v40, v40
    v_exp_f32 v41, v41
    v_exp_f32 v42, v42
    v_exp_f32 v43, v43
    v_exp_f32 v44, v44
    v_smfmac_f32_32x32x32_bf16 v[64:79], v[136:139], v[32:39], v2
    v_exp_f32 v45, v45
    v_exp_f32 v46, v46
    v_exp_f32 v47, v47
    s_nop 1
    v_exp_f32 v16, v16
    v_exp_f32 v17, v17
    v_smfmac_f32_32x32x32_bf16 v[64:79], v[140:143], v[40:47], v2
    s_waitcnt lgkmcnt(0)
    ds_read_b128 v[124:127], v3 offset:14560
    v_exp_f32 v18, v18
    v_exp_f32 v19, v19
    v_exp_f32 v20, v20
    v_exp_f32 v21, v21
    v_exp_f32 v22, v22
    v_mfma_f32_32x32x16_bf16 v[32:47], v[120:123], v[116:119], v[96:111]
    ds_read_b128 v[136:139], v4 offset:14560
    v_exp_f32 v23, v23
    v_exp_f32 v24, v24
    v_exp_f32 v25, v25
    v_exp_f32 v26, v26
    v_exp_f32 v27, v27
    v_exp_f32 v28, v28
    v_smfmac_f32_32x32x32_bf16 v[48:63], v[128:131], v[16:23], v2
    ds_read_b128 v[140:143], v5 offset:14560
    v_exp_f32 v29, v29
    v_exp_f32 v30, v30
    v_exp_f32 v31, v31
    v_exp_f32 v32, v32
    v_exp_f32 v33, v33
    v_smfmac_f32_32x32x32_bf16 v[48:63], v[132:135], v[24:31], v2
    s_waitcnt lgkmcnt(2)
    v_exp_f32 v34, v34
    v_exp_f32 v35, v35
    v_exp_f32 v36, v36
    v_exp_f32 v37, v37
    v_exp_f32 v38, v38
    v_mfma_f32_32x32x16_bf16 v[16:31], v[124:127], v[112:115], v[80:95]
    v_exp_f32 v39, v39
    v_exp_f32 v40, v40
    v_exp_f32 v41, v41
    v_exp_f32 v42, v42
    v_exp_f32 v43, v43
    v_exp_f32 v44, v44
    v_smfmac_f32_32x32x32_bf16 v[64:79], v[128:131], v[32:39], v2
    ds_read_b32 v9, v7 offset:33280
    v_exp_f32 v45, v45
    v_exp_f32 v46, v46
    v_exp_f32 v47, v47
    s_nop 0
    v_exp_f32 v16, v16
    v_exp_f32 v17, v17
    v_smfmac_f32_32x32x32_bf16 v[64:79], v[132:135], v[40:47], v2
    s_waitcnt lgkmcnt(0)
    v_cmp_gt_u32 vcc, s35, v9
    s_cbranch_vccnz AT_SPIN7
AT_BACK7:
    ds_read_b128 v[120:123], v3 offset:16640
    v_exp_f32 v18, v18
    v_exp_f32 v19, v19
    v_exp_f32 v20, v20
    v_exp_f32 v21, v21
    v_exp_f32 v22, v22
    v_mfma_f32_32x32x16_bf16 v[32:47], v[124:127], v[116:119], v[96:111]
    ds_read_b128 v[128:131], v4 offset:16640
    v_exp_f32 v23, v23
    v_exp_f32 v24, v24
    v_exp_f32 v25, v25
    v_exp_f32 v26, v26
    v_exp_f32 v27, v27
    v_exp_f32 v28, v28
    v_smfmac_f32_32x32x32_bf16 v[48:63], v[136:139], v[16:23], v2
    ds_read_b128 v[132:135], v5 offset:16640
    s_add_u32 m0, s34, 0
    s_add_u32 s35, s35, 1
    v_exp_f32 v29, v29
    v_exp_f32 v30, v30
    v_exp_f32 v31, v31
    v_exp_f32 v32, v32
    v_exp_f32 v33, v33
    v_smfmac_f32_32x32x32_bf16 v[48:63], v[140:143], v[24:31], v2
    s_waitcnt lgkmcnt(2)
    buffer_load_dwordx4 v3, s[8:11], s33 offen sc1 lds
    v_exp_f32 v34, v34
    v_exp_f32 v35, v35
    v_exp_f32 v36, v36
    v_exp_f32 v37, v37
    v_exp_f32 v38, v38
    v_mfma_f32_32x32x16_bf16 v[16:31], v[120:123], v[112:115], v[80:95]
    v_exp_f32 v39, v39
    v_exp_f32 v40, v40
    v_exp_f32 v41, v41
    v_exp_f32 v42, v42
    v_exp_f32 v43, v43
    v_exp_f32 v44, v44
    v_smfmac_f32_32x32x32_bf16 v[64:79], v[136:139], v[32:39], v2
    buffer_load_dwordx4 v3, s[8:11], s33 offen offset:1024 sc1 lds
    s_add_u32 s33, s33, 8192
    s_and_b32 s33, s33, 0x1ffff
    v_exp_f32 v45, v45
    v_exp_f32 v46, v46
    v_exp_f32 v47, v47
    v_exp_f32 v16, v16
    v_exp_f32 v17, v17
    v_smfmac_f32_32x32x32_bf16 v[64:79], v[140:143], v[40:47], v2
    s_waitcnt lgkmcnt(0)
    ds_read_b128 v[124:127], v3 offset:18720
    v_exp_f32 v18, v18
    v_exp_f32 v19, v19
    v_exp_f32 v20, v20
    v_exp_f32 v21, v21
    v_exp_f32 v22, v22
    v_mfma_f32_32x32x16_bf16 v[32:47], v[120:123], v[116:119], v[96:111]
    ds_read_b128 v[136:139], v4 offset:18720
    v_exp_f32 v23, v23
    v_exp_f32 v24, v24
    v_exp_f32 v25, v25
    v_exp_f32 v26, v26
    v_exp_f32 v27, v27
    v_exp_f32 v28, v28
    v_smfmac_f32_32x32x32_bf16 v[48:63], v[128:131], v[16:23], v2
    ds_read_b128 v[140:143], v5 offset:18720
    v_exp_f32 v29, v29
    v_exp_f32 v30, v30
    v_exp_f32 v31, v31
    v_exp_f32 v32, v32
    v_exp_f32 v33, v33
    v_smfmac_f32_32x32x32_bf16 v[48:63], v[132:135], v[24:31], v2
    s_waitcnt lgkmcnt(2)
    v_exp_f32 v34, v34
    v_exp_f32 v35, v35
    v_exp_f32 v36, v36
    v_exp_f32 v37, v37
    v_exp_f32 v38, v38
    v_mfma_f32_32x32x16_bf16 v[16:31], v[124:127], v[112:115], v[80:95]
    v_add_u32 v8, 1, v8
    v_exp_f32 v39, v39
    v_exp_f32 v40, v40
    v_exp_f32 v41, v41
    v_exp_f32 v42, v42
    v_exp_f32 v43, v43
    v_exp_f32 v44, v44
    v_smfmac_f32_32x32x32_bf16 v[64:79], v[128:131], v[32:39], v2
    s_waitcnt vmcnt(2)
    ds_write_b32 v6, v8 offset:33280
    v_exp_f32 v45, v45
    v_exp_f32 v46, v46
    v_exp_f32 v47, v47
    v_exp_f32 v16, v16
    v_exp_f32 v17, v17
    v_smfmac_f32_32x32x32_bf16 v[64:79], v[132:135], v[40:47], v2
    s_waitcnt lgkmcnt(0)
    ds_read_b128 v[120:123], v3 offset:20800
    v_exp_f32 v18, v18
    v_exp_f32 v19, v19
    v_exp_f32 v20, v20
    v_exp_f32 v21, v21
    v_exp_f32 v22, v22
    v_mfma_f32_32x32x16_bf16 v[32:47], v[124:127], v[116:119], v[96:111]
    ds_read_b128 v[128:131], v4 offset:20800
    v_exp_f32 v23, v23
    v_exp_f32 v24, v24
    v_exp_f32 v25, v25
    v_exp_f32 v26, v26
    v_exp_f32 v27, v27
    v_exp_f32 v28, v28
    v_smfmac_f32_32x32x32_bf16 v[48:63], v[136:139], v[16:23], v2
    ds_read_b128 v[132:135], v5 offset:20800
    v_exp_f32 v29, v29
    v_exp_f32 v30, v30
    v_exp_f32 v31, v31
    v_exp_f32 v32, v32
    v_exp_f32 v33, v33
    v_smfmac_f32_32x32x32_bf16 v[48:63], v[140:143], v[24:31], v2
    s_waitcnt lgkmcnt(2)
    v_exp_f32 v34, v34
    v_exp_f32 v35, v35
    v_exp_f32 v36, v36
    v_exp_f32 v37, v37
    v_exp_f32 v38, v38
    v_mfma_f32_32x32x16_bf16 v[16:31], v[120:123], v[112:115], v[80:95]
    v_exp_f32 v39, v39
    v_exp_f32 v40, v40
    v_exp_f32 v41, v41
    v_exp_f32 v42, v42
    v_exp_f32 v43, v43
    v_exp_f32 v44, v44
    v_smfmac_f32_32x32x32_bf16 v[64:79], v[136:139], v[32:39], v2
    v_exp_f32 v45, v45
    v_exp_f32 v46, v46
    v_exp_f32 v47, v47
    s_nop 1
    v_exp_f32 v16, v16
    v_exp_f32 v17, v17
    v_smfmac_f32_32x32x32_bf16 v[64:79], v[140:143], v[40:47], v2
    s_waitcnt lgkmcnt(0)
    ds_read_b128 v[124:127], v3 offset:22880
    v_exp_f32 v18, v18
    v_exp_f32 v19, v19
    v_exp_f32 v20, v20
    v_exp_f32 v21, v21
    v_exp_f32 v22, v22
    v_mfma_f32_32x32x16_bf16 v[32:47], v[120:123], v[116:119], v[96:111]
    ds_read_b128 v[136:139], v4 offset:22880
    v_exp_f32 v23, v23
    v_exp_f32 v24, v24
    v_exp_f32 v25, v25
    v_exp_f32 v26, v26
    v_exp_f32 v27, v27
    v_exp_f32 v28, v28
    v_smfmac_f32_32x32x32_bf16 v[48:63], v[128:131], v[16:23], v2
    ds_read_b128 v[140:143], v5 offset:22880
    v_exp_f32 v29, v29
    v_exp_f32 v30, v30
    v_exp_f32 v31, v31
    v_exp_f32 v32, v32
    v_exp_f32 v33, v33
    v_smfmac_f32_32x32x32_bf16 v[48:63], v[132:135], v[24:31], v2
    s_waitcnt lgkmcnt(2)
    v_exp_f32 v34, v34
    v_exp_f32 v35, v35
    v_exp_f32 v36, v36
    v_exp_f32 v37, v37
    v_exp_f32 v38, v38
    v_mfma_f32_32x32x16_bf16 v[16:31], v[124:127], v[112:115], v[80:95]
    v_exp_f32 v39, v39
    v_exp_f32 v40, v40
    v_exp_f32 v41, v41
    v_exp_f32 v42, v42
    v_exp_f32 v43, v43
    v_exp_f32 v44, v44
    v_smfmac_f32_32x32x32_bf16 v[64:79], v[128:131], v[32:39], v2
    ds_read_b32 v9, v7 offset:33280
    v_exp_f32 v45, v45
    v_exp_f32 v46, v46
    v_exp_f32 v47, v47
    s_nop 0
    v_exp_f32 v16, v16
    v_exp_f32 v17, v17
    v_smfmac_f32_32x32x32_bf16 v[64:79], v[132:135], v[40:47], v2
    s_waitcnt lgkmcnt(0)
    v_cmp_gt_u32 vcc, s35, v9
    s_cbranch_vccnz AT_SPIN11
AT_BACK11:
    ds_read_b128 v[120:123], v3 offset:24960
    v_exp_f32 v18, v18
    v_exp_f32 v19, v19
    v_exp_f32 v20, v20
    v_exp_f32 v21, v21
    v_exp_f32 v22, v22
    v_mfma_f32_32x32x16_bf16 v[32:47], v[124:127], v[116:119], v[96:111]
    ds_read_b128 v[128:131], v4 offset:24960
    v_exp_f32 v23, v23
    v_exp_f32 v24, v24
    v_exp_f32 v25, v25
    v_exp_f32 v26, v26
    v_exp_f32 v27, v27
    v_exp_f32 v28, v28
    v_smfmac_f32_32x32x32_bf16 v[48:63], v[136:139], v[16:23], v2
    ds_read_b128 v[132:135], v5 offset:24960
    s_add_u32 m0, s34, 8320
    s_add_u32 s35, s35, 1
    v_exp_f32 v29, v29
    v_exp_f32 v30, v30
    v_exp_f32 v31, v31
    v_exp_f32 v32, v32
    v_exp_f32 v33, v33
    v_smfmac_f32_32x32x32_bf16 v[48:63], v[140:143], v[24:31], v2
    s_waitcnt lgkmcnt(2)
    buffer_load_dwordx4 v3, s[8:11], s33 offen sc1 lds
    v_exp_f32 v34, v34
    v_exp_f32 v35, v35
    v_exp_f32 v36, v36
    v_exp_f32 v37, v37
    v_exp_f32 v38, v38
    v_mfma_f32_32x32x16_bf16 v[16:31], v[120:123], v[112:115], v[80:95]
    v_exp_f32 v39, v39
    v_exp_f32 v40, v40
    v_exp_f32 v41, v41
    v_exp_f32 v42, v42
    v_exp_f32 v43, v43
    v_exp_f32 v44, v44
    v_smfmac_f32_32x32x32_bf16 v[64:79], v[136:139], v[32:39], v2
    buffer_load_dwordx4 v3, s[8:11], s33 offen offset:1024 sc1 lds
    s_add_u32 s33, s33, 8192
    s_and_b32 s33, s33, 0x1ffff
    v_exp_f32 v45, v45
    v_exp_f32 v46, v46
    v_exp_f32 v47, v47
    v_exp_f32 v16, v16
    v_exp_f32 v17, v17
    v_smfmac_f32_32x32x32_bf16 v[64:79], v[140:143], v[40:47], v2
    s_waitcnt lgkmcnt(0)
    ds_read_b128 v[124:127], v3 offset:27040
    v_exp_f32 v18, v18
    v_exp_f32 v19, v19
    v_exp_f32 v20, v20
    v_exp_f32 v21, v21
    v_exp_f32 v22, v22
    v_mfma_f32_32x32x16_bf16 v[32:47], v[120:123], v[116:119], v[96:111]
    ds_read_b128 v[136:139], v4 offset:27040
    v_exp_f32 v23, v23
    v_exp_f32 v24, v24
    v_exp_f32 v25, v25
    v_exp_f32 v26, v26
    v_exp_f32 v27, v27
    v_exp_f32 v28, v28
    v_smfmac_f32_32x32x32_bf16 v[48:63], v[128:131], v[16:23], v2
    ds_read_b128 v[140:143], v5 offset:27040
    v_exp_f32 v29, v29
    v_exp_f32 v30, v30
    v_exp_f32 v31, v31
    v_exp_f32 v32, v32
    v_exp_f32 v33, v33
    v_smfmac_f32_32x32x32_bf16 v[48:63], v[132:135], v[24:31], v2
    s_waitcnt lgkmcnt(2)
    v_exp_f32 v34, v34
    v_exp_f32 v35, v35
    v_exp_f32 v36, v36
    v_exp_f32 v37, v37
    v_exp_f32 v38, v38
    v_mfma_f32_32x32x16_bf16 v[16:31], v[124:127], v[112:115], v[80:95]
    v_add_u32 v8, 1, v8
    v_exp_f32 v39, v39
    v_exp_f32 v40, v40
    v_exp_f32 v41, v41
    v_exp_f32 v42, v42
    v_exp_f32 v43, v43
    v_exp_f32 v44, v44
    v_smfmac_f32_32x32x32_bf16 v[64:79], v[128:131], v[32:39], v2
    s_waitcnt vmcnt(2)
    ds_write_b32 v6, v8 offset:33280
    v_exp_f32 v45, v45
    v_exp_f32 v46, v46
    v_exp_f32 v47, v47
    v_exp_f32 v16, v16
    v_exp_f32 v17, v17
    v_smfmac_f32_32x32x32_bf16 v[64:79], v[132:135], v[40:47], v2
    s_waitcnt lgkmcnt(0)
    ds_read_b128 v[120:123], v3 offset:29120
    v_exp_f32 v18, v18
    v_exp_f32 v19, v19
    v_exp_f32 v20, v20
    v_exp_f32 v21, v21
    v_exp_f32 v22, v22
    v_mfma_f32_32x32x16_bf16 v[32:47], v[124:127], v[116:119], v[96:111]
    ds_read_b128 v[128:131], v4 offset:29120
    v_exp_f32 v23, v23
    v_exp_f32 v24, v24
    v_exp_f32 v25, v25
    v_exp_f32 v26, v26
    v_exp_f32 v27, v27
    v_exp_f32 v28, v28
    v_smfmac_f32_32x32x32_bf16 v[48:63], v[136:139], v[16:23], v2
    ds_read_b128 v[132:135], v5 offset:29120
    v_exp_f32 v29, v29
    v_exp_f32 v30, v30
    v_exp_f32 v31, v31
    v_exp_f32 v32, v32
    v_exp_f32 v33, v33
    v_smfmac_f32_32x32x32_bf16 v[48:63], v[140:143], v[24:31], v2
    s_waitcnt lgkmcnt(2)
    v_exp_f32 v34, v34
    v_exp_f32 v35, v35
    v_exp_f32 v36, v36
    v_exp_f32 v37, v37
    v_exp_f32 v38, v38
    v_mfma_f32_32x32x16_bf16 v[16:31], v[120:123], v[112:115], v[80:95]
    v_exp_f32 v39, v39
    v_exp_f32 v40, v40
    v_exp_f32 v41, v41
    v_exp_f32 v42, v42
    v_exp_f32 v43, v43
    v_exp_f32 v44, v44
    v_smfmac_f32_32x32x32_bf16 v[64:79], v[136:139], v[32:39], v2
    v_exp_f32 v45, v45
    v_exp_f32 v46, v46
    v_exp_f32 v47, v47
    s_nop 1
    v_exp_f32 v16, v16
    v_exp_f32 v17, v17
    v_smfmac_f32_32x32x32_bf16 v[64:79], v[140:143], v[40:47], v2
    s_waitcnt lgkmcnt(0)
    ds_read_b128 v[124:127], v3 offset:31200
    v_exp_f32 v18, v18
    v_exp_f32 v19, v19
    v_exp_f32 v20, v20
    v_exp_f32 v21, v21
    v_exp_f32 v22, v22
    v_mfma_f32_32x32x16_bf16 v[32:47], v[120:123], v[116:119], v[96:111]
    ds_read_b128 v[136:139], v4 offset:31200
    v_exp_f32 v23, v23
    v_exp_f32 v24, v24
    v_exp_f32 v25, v25
    v_exp_f32 v26, v26
    v_exp_f32 v27, v27
    v_exp_f32 v28, v28
    v_smfmac_f32_32x32x32_bf16 v[48:63], v[128:131], v[16:23], v2
    ds_read_b128 v[140:143], v5 offset:31200
    v_exp_f32 v29, v29
    v_exp_f32 v30, v30
    v_exp_f32 v31, v31
    v_exp_f32 v32, v32
    v_exp_f32 v33, v33
    v_smfmac_f32_32x32x32_bf16 v[48:63], v[132:135], v[24:31], v2
    s_waitcnt lgkmcnt(2)
    v_exp_f32 v34, v34
    v_exp_f32 v35, v35
    v_exp_f32 v36, v36
    v_exp_f32 v37, v37
    v_exp_f32 v38, v38
    v_mfma_f32_32x32x16_bf16 v[16:31], v[124:127], v[112:115], v[80:95]
    v_exp_f32 v39, v39
    v_exp_f32 v40, v40
    v_exp_f32 v41, v41
    v_exp_f32 v42, v42
    v_exp_f32 v43, v43
    v_exp_f32 v44, v44
    v_smfmac_f32_32x32x32_bf16 v[64:79], v[128:131], v[32:39], v2
    ds_read_b32 v9, v7 offset:33280
    v_exp_f32 v45, v45
    v_exp_f32 v46, v46
    v_exp_f32 v47, v47
    s_nop 0
    v_exp_f32 v16, v16
    v_exp_f32 v17, v17
    v_smfmac_f32_32x32x32_bf16 v[64:79], v[132:135], v[40:47], v2
    s_waitcnt lgkmcnt(0)
    v_cmp_gt_u32 vcc, s35, v9
    s_cbranch_vccnz AT_SPIN15
AT_BACK15:
    ds_read_b128 v[120:123], v3 offset:0
    v_exp_f32 v18, v18
    v_exp_f32 v19, v19
    v_exp_f32 v20, v20
    v_exp_f32 v21, v21
    v_exp_f32 v22, v22
    v_mfma_f32_32x32x16_bf16 v[32:47], v[124:127], v[116:119], v[96:111]
    ds_read_b128 v[128:131], v4 offset:0
    v_exp_f32 v23, v23
    v_exp_f32 v24, v24
    v_exp_f32 v25, v25
    v_exp_f32 v26, v26
    v_exp_f32 v27, v27
    v_exp_f32 v28, v28
    v_smfmac_f32_32x32x32_bf16 v[48:63], v[136:139], v[16:23], v2
    ds_read_b128 v[132:135], v5 offset:0
    s_add_u32 m0, s34, 16640
    s_add_u32 s35, s35, 1
    v_exp_f32 v29, v29
    v_exp_f32 v30, v30
    v_exp_f32 v31, v31
    v_exp_f32 v32, v32
    v_exp_f32 v33, v33
    v_smfmac_f32_32x32x32_bf16 v[48:63], v[140:143], v[24:31], v2
    s_waitcnt lgkmcnt(2)
    buffer_load_dwordx4 v3, s[8:11], s33 offen sc1 lds
    v_exp_f32 v34, v34
    v_exp_f32 v35, v35
    v_exp_f32 v36, v36
    v_exp_f32 v37, v37
    v_exp_f32 v38, v38
    v_mfma_f32_32x32x16_bf16 v[16:31], v[120:123], v[112:115], v[80:95]
    v_exp_f32 v39, v39
    v_exp_f32 v40, v40
    v_exp_f32 v41, v41
    v_exp_f32 v42, v42
    v_exp_f32 v43, v43
    v_exp_f32 v44, v44
    v_smfmac_f32_32x32x32_bf16 v[64:79], v[136:139], v[32:39], v2
    buffer_load_dwordx4 v3, s[8:11], s33 offen offset:1024 sc1 lds
    s_add_u32 s33, s33, 8192
    s_and_b32 s33, s33, 0x1ffff
    v_exp_f32 v45, v45
    s_sub_u32 s36, s36, 1
    s_cmp_lg_u32 s36, 0
    v_exp_f32 v46, v46
    v_exp_f32 v47, v47
    s_cbranch_scc1 AT_LOOP
    v_exp_f32 v16, v16
    v_exp_f32 v17, v17
    v_smfmac_f32_32x32x32_bf16 v[64:79], v[140:143], v[40:47], v2
    s_waitcnt lgkmcnt(0)
    ds_read_b128 v[124:127], v3 offset:2080
    v_exp_f32 v18, v18
    v_exp_f32 v19, v19
    v_exp_f32 v20, v20
    v_exp_f32 v21, v21
    v_exp_f32 v22, v22
    v_mfma_f32_32x32x16_bf16 v[32:47], v[120:123], v[116:119], v[96:111]
    ds_read_b128 v[136:139], v4 offset:2080
    v_exp_f32 v23, v23
    v_exp_f32 v24, v24
    v_exp_f32 v25, v25
    v_exp_f32 v26, v26
    v_exp_f32 v27, v27
    v_exp_f32 v28, v28
    v_smfmac_f32_32x32x32_bf16 v[48:63], v[128:131], v[16:23], v2
    ds_read_b128 v[140:143], v5 offset:2080
    v_exp_f32 v29, v29
    v_exp_f32 v30, v30
    v_exp_f32 v31, v31
    v_exp_f32 v32, v32
    v_exp_f32 v33, v33
    v_smfmac_f32_32x32x32_bf16 v[48:63], v[132:135], v[24:31], v2
    s_waitcnt lgkmcnt(2)
    v_exp_f32 v34, v34
    v_exp_f32 v35, v35
    v_exp_f32 v36, v36
    v_exp_f32 v37, v37
    v_exp_f32 v38, v38
    v_mfma_f32_32x32x16_bf16 v[16:31], v[124:127], v[112:115], v[80:95]
    v_add_u32 v8, 1, v8
    v_exp_f32 v39, v39
    v_exp_f32 v40, v40
    v_exp_f32 v41, v41
    v_exp_f32 v42, v42
    v_exp_f32 v43, v43
    v_exp_f32 v44, v44
    v_smfmac_f32_32x32x32_bf16 v[64:79], v[128:131], v[32:39], v2
    s_waitcnt vmcnt(2)
    ds_write_b32 v6, v8 offset:33280
    v_exp_f32 v45, v45
    v_exp_f32 v46, v46
    v_exp_f32 v47, v47
    v_exp_f32 v16, v16
    v_exp_f32 v17, v17
    v_smfmac_f32_32x32x32_bf16 v[64:79], v[132:135], v[40:47], v2
    s_waitcnt lgkmcnt(0)
    ds_read_b128 v[120:123], v3 offset:4160
    v_exp_f32 v18, v18
    v_exp_f32 v19, v19
    v_exp_f32 v20, v20
    v_exp_f32 v21, v21
    v_exp_f32 v22, v22
    v_mfma_f32_32x32x16_bf16 v[32:47], v[124:127], v[116:119], v[96:111]
    ds_read_b128 v[128:131], v4 offset:4160
    v_exp_f32 v23, v23
    v_exp_f32 v24, v24
    v_exp_f32 v25, v25
    v_exp_f32 v26, v26
    v_exp_f32 v27, v27
    v_exp_f32 v28, v28
    v_smfmac_f32_32x32x32_bf16 v[48:63], v[136:139], v[16:23], v2
    ds_read_b128 v[132:135], v5 offset:4160
    v_exp_f32 v29, v29
    v_exp_f32 v30, v30
    v_exp_f32 v31, v31
    v_exp_f32 v32, v32
    v_exp_f32 v33, v33
    v_smfmac_f32_32x32x32_bf16 v[48:63], v[140:143], v[24:31], v2
    s_waitcnt lgkmcnt(2)
    v_exp_f32 v34, v34
    v_exp_f32 v35, v35
    v_exp_f32 v36, v36
    v_exp_f32 v37, v37
    v_exp_f32 v38, v38
    v_mfma_f32_32x32x16_bf16 v[16:31], v[120:123], v[112:115], v[80:95]
    v_exp_f32 v39, v39
    v_exp_f32 v40, v40
    v_exp_f32 v41, v41
    v_exp_f32 v42, v42
    v_exp_f32 v43, v43
    v_exp_f32 v44, v44
    v_smfmac_f32_32x32x32_bf16 v[64:79], v[136:139], v[32:39], v2
    v_exp_f32 v45, v45
    v_exp_f32 v46, v46
    v_exp_f32 v47, v47
    s_nop 1
    v_exp_f32 v16, v16
    v_exp_f32 v17, v17
    v_smfmac_f32_32x32x32_bf16 v[64:79], v[140:143], v[40:47], v2
    s_waitcnt lgkmcnt(0)
    ds_read_b128 v[124:127], v3 offset:6240
    v_exp_f32 v18, v18
    v_exp_f32 v19, v19
    v_exp_f32 v20, v20
    v_exp_f32 v21, v21
    v_exp_f32 v22, v22
    v_mfma_f32_32x32x16_bf16 v[32:47], v[120:123], v[116:119], v[96:111]
    ds_read_b128 v[136:139], v4 offset:6240
    v_exp_f32 v23, v23
    v_exp_f32 v24, v24
    v_exp_f32 v25, v25
    v_exp_f32 v26, v26
    v_exp_f32 v27, v27
    v_exp_f32 v28, v28
    v_smfmac_f32_32x32x32_bf16 v[48:63], v[128:131], v[16:23], v2
    ds_read_b128 v[140:143], v5 offset:6240
    v_exp_f32 v29, v29
    v_exp_f32 v30, v30
    v_exp_f32 v31, v31
    v_exp_f32 v32, v32
    v_exp_f32 v33, v33
    v_smfmac_f32_32x32x32_bf16 v[48:63], v[132:135], v[24:31], v2
    s_waitcnt lgkmcnt(2)
    v_exp_f32 v34, v34
    v_exp_f32 v35, v35
    v_exp_f32 v36, v36
    v_exp_f32 v37, v37
    v_exp_f32 v38, v38
    v_mfma_f32_32x32x16_bf16 v[16:31], v[124:127], v[112:115], v[80:95]
    v_exp_f32 v39, v39
    v_exp_f32 v40, v40
    v_exp_f32 v41, v41
    v_exp_f32 v42, v42
    v_exp_f32 v43, v43
    v_exp_f32 v44, v44
    v_smfmac_f32_32x32x32_bf16 v[64:79], v[128:131], v[32:39], v2
    ds_read_b32 v9, v7 offset:33280
    v_exp_f32 v45, v45
    v_exp_f32 v46, v46
    v_exp_f32 v47, v47
    s_nop 0
    v_exp_f32 v16, v16
    v_exp_f32 v17, v17
    v_smfmac_f32_32x32x32_bf16 v[64:79], v[132:135], v[40:47], v2
    s_waitcnt lgkmcnt(0)
    v_cmp_gt_u32 vcc, s35, v9
    s_cbranch_vccnz AT_SPINZ3
AT_BACKZ3:
    ds_read_b128 v[120:123], v3 offset:8320
    v_exp_f32 v18, v18
    v_exp_f32 v19, v19
    v_exp_f32 v20, v20
    v_exp_f32 v21, v21
    v_exp_f32 v22, v22
    v_mfma_f32_32x32x16_bf16 v[32:47], v[124:127], v[116:119], v[96:111]
    ds_read_b128 v[128:131], v4 offset:8320
    v_exp_f32 v23, v23
    v_exp_f32 v24, v24
    v_exp_f32 v25, v25
    v_exp_f32 v26, v26
    v_exp_f32 v27, v27
    v_exp_f32 v28, v28
    v_smfmac_f32_32x32x32_bf16 v[48:63], v[136:139], v[16:23], v2
    ds_read_b128 v[132:135], v5 offset:8320
    s_add_u32 m0, s34, 24960
    s_add_u32 s35, s35, 1
    v_exp_f32 v29, v29
    v_exp_f32 v30, v30
    v_exp_f32 v31, v31
    v_exp_f32 v32, v32
    v_exp_f32 v33, v33
    v_smfmac_f32_32x32x32_bf16 v[48:63], v[140:143], v[24:31], v2
    s_waitcnt lgkmcnt(2)
    buffer_load_dwordx4 v3, s[8:11], s33 offen sc1 lds
    v_exp_f32 v34, v34
    v_exp_f32 v35, v35
    v_exp_f32 v36, v36
    v_exp_f32 v37, v37
    v_exp_f32 v38, v38
    v_mfma_f32_32x32x16_bf16 v[16:31], v[120:123], v[112:115], v[80:95]
    v_exp_f32 v39, v39
    v_exp_f32 v40, v40
    v_exp_f32 v41, v41
    v_exp_f32 v42, v42
    v_exp_f32 v43, v43
    v_exp_f32 v44, v44
    v_smfmac_f32_32x32x32_bf16 v[64:79], v[136:139], v[32:39], v2
    buffer_load_dwordx4 v3, s[8:11], s33 offen offset:1024 sc1 lds
    s_add_u32 s33, s33, 8192
    s_and_b32 s33, s33, 0x1ffff
    v_exp_f32 v45, v45
    v_exp_f32 v46, v46
    v_exp_f32 v47, v47
    v_exp_f32 v16, v16
    v_exp_f32 v17, v17
    v_smfmac_f32_32x32x32_bf16 v[64:79], v[140:143], v[40:47], v2
    s_waitcnt lgkmcnt(0)
    ds_read_b128 v[124:127], v3 offset:10400
    v_exp_f32 v18, v18
    v_exp_f32 v19, v19
    v_exp_f32 v20, v20
    v_exp_f32 v21, v21
    v_exp_f32 v22, v22
    v_mfma_f32_32x32x16_bf16 v[32:47], v[120:123], v[116:119], v[96:111]
    ds_read_b128 v[136:139], v4 offset:10400
    v_exp_f32 v23, v23
    v_exp_f32 v24, v24
    v_exp_f32 v25, v25
    v_exp_f32 v26, v26
    v_exp_f32 v27, v27
    v_exp_f32 v28, v28
    v_smfmac_f32_32x32x32_bf16 v[48:63], v[128:131], v[16:23], v2
    ds_read_b128 v[140:143], v5 offset:10400
    v_exp_f32 v29, v29
    v_exp_f32 v30, v30
    v_exp_f32 v31, v31
    v_exp_f32 v32, v32
    v_exp_f32 v33, v33
    v_smfmac_f32_32x32x32_bf16 v[48:63], v[132:135], v[24:31], v2
    s_waitcnt lgkmcnt(2)
    v_exp_f32 v34, v34
    v_exp_f32 v35, v35
    v_exp_f32 v36, v36
    v_exp_f32 v37, v37
    v_exp_f32 v38, v38
    v_mfma_f32_32x32x16_bf16 v[16:31], v[124:127], v[112:115], v[80:95]
    v_add_u32 v8, 1, v8
    v_exp_f32 v39, v39
    v_exp_f32 v40, v40
    v_exp_f32 v41, v41
    v_exp_f32 v42, v42
    v_exp_f32 v43, v43
    v_exp_f32 v44, v44
    v_smfmac_f32_32x32x32_bf16 v[64:79], v[128:131], v[32:39], v2
    s_waitcnt vmcnt(2)
    ds_write_b32 v6, v8 offset:33280
    v_exp_f32 v45, v45
    v_exp_f32 v46, v46
    v_exp_f32 v47, v47
    v_exp_f32 v16, v16
    v_exp_f32 v17, v17
    v_smfmac_f32_32x32x32_bf16 v[64:79], v[132:135], v[40:47], v2
    s_waitcnt lgkmcnt(0)
    ds_read_b128 v[120:123], v3 offset:12480
    v_exp_f32 v18, v18
    v_exp_f32 v19, v19
    v_exp_f32 v20, v20
    v_exp_f32 v21, v21
    v_exp_f32 v22, v22
    v_mfma_f32_32x32x16_bf16 v[32:47], v[124:127], v[116:119], v[96:111]
    ds_read_b128 v[128:131], v4 offset:12480
    v_exp_f32 v23, v23
    v_exp_f32 v24, v24
    v_exp_f32 v25, v25
    v_exp_f32 v26, v26
    v_exp_f32 v27, v27
    v_exp_f32 v28, v28
    v_smfmac_f32_32x32x32_bf16 v[48:63], v[136:139], v[16:23], v2
    ds_read_b128 v[132:135], v5 offset:12480
    v_exp_f32 v29, v29
    v_exp_f32 v30, v30
    v_exp_f32 v31, v31
    v_exp_f32 v32, v32
    v_exp_f32 v33, v33
    v_smfmac_f32_32x32x32_bf16 v[48:63], v[140:143], v[24:31], v2
    s_waitcnt lgkmcnt(2)
    v_exp_f32 v34, v34
    v_exp_f32 v35, v35
    v_exp_f32 v36, v36
    v_exp_f32 v37, v37
    v_exp_f32 v38, v38
    v_mfma_f32_32x32x16_bf16 v[16:31], v[120:123], v[112:115], v[80:95]
    s_mov_b64 exec, 1
    buffer_atomic_umax v12, v14, s[12:15], s52 offen sc0 sc1
    s_mov_b64 exec, -1
    v_exp_f32 v39, v39
    v_exp_f32 v40, v40
    v_exp_f32 v41, v41
    v_exp_f32 v42, v42
    v_exp_f32 v43, v43
    v_exp_f32 v44, v44
    v_smfmac_f32_32x32x32_bf16 v[64:79], v[136:139], v[32:39], v2
    v_exp_f32 v45, v45
    v_exp_f32 v46, v46
    v_exp_f32 v47, v47
    v_exp_f32 v16, v16
    v_exp_f32 v17, v17
    v_smfmac_f32_32x32x32_bf16 v[64:79], v[140:143], v[40:47], v2
    s_waitcnt lgkmcnt(0)
    ds_read_b128 v[124:127], v3 offset:14560
    v_exp_f32 v18, v18
    v_exp_f32 v19, v19
    v_exp_f32 v20, v20
    v_exp_f32 v21, v21
    v_exp_f32 v22, v22
    v_mfma_f32_32x32x16_bf16 v[32:47], v[120:123], v[116:119], v[96:111]
    ds_read_b128 v[136:139], v4 offset:14560
    v_exp_f32 v23, v23
    v_exp_f32 v24, v24
    v_exp_f32 v25, v25
    v_exp_f32 v26, v26
    v_exp_f32 v27, v27
    v_exp_f32 v28, v28
    v_smfmac_f32_32x32x32_bf16 v[48:63], v[128:131], v[16:23], v2
    ds_read_b128 v[140:143], v5 offset:14560
    v_exp_f32 v29, v29
    v_exp_f32 v30, v30
    v_exp_f32 v31, v31
    v_exp_f32 v32, v32
    v_exp_f32 v33, v33
    v_smfmac_f32_32x32x32_bf16 v[48:63], v[132:135], v[24:31], v2
    s_waitcnt lgkmcnt(2)
    v_exp_f32 v34, v34
    v_exp_f32 v35, v35
    v_exp_f32 v36, v36
    v_exp_f32 v37, v37
    v_exp_f32 v38, v38
    v_mfma_f32_32x32x16_bf16 v[16:31], v[124:127], v[112:115], v[80:95]
    v_exp_f32 v39, v39
    v_exp_f32 v40, v40
    v_exp_f32 v41, v41
    v_exp_f32 v42, v42
    v_exp_f32 v43, v43
    v_exp_f32 v44, v44
    v_smfmac_f32_32x32x32_bf16 v[64:79], v[128:131], v[32:39], v2
    ds_read_b32 v9, v7 offset:33280
    v_exp_f32 v45, v45
    v_exp_f32 v46, v46
    v_exp_f32 v47, v47
    s_nop 0
    v_exp_f32 v16, v16
    v_exp_f32 v17, v17
    v_smfmac_f32_32x32x32_bf16 v[64:79], v[132:135], v[40:47], v2
    s_waitcnt lgkmcnt(0)
    v_cmp_gt_u32 vcc, s35, v9
    s_cbranch_vccnz AT_SPINZ7
AT_BACKZ7:
    ds_read_b128 v[120:123], v3 offset:16640
    v_exp_f32 v18, v18
    v_exp_f32 v19, v19
    v_exp_f32 v20, v20
    v_exp_f32 v21, v21
    v_exp_f32 v22, v22
    v_mfma_f32_32x32x16_bf16 v[32:47], v[124:127], v[116:119], v[96:111]
    ds_read_b128 v[128:131], v4 offset:16640
    v_exp_f32 v23, v23
    v_exp_f32 v24, v24
    v_exp_f32 v25, v25
    v_exp_f32 v26, v26
    v_exp_f32 v27, v27
    v_exp_f32 v28, v28
    v_smfmac_f32_32x32x32_bf16 v[48:63], v[136:139], v[16:23], v2
    ds_read_b128 v[132:135], v5 offset:16640
    v_exp_f32 v29, v29
    v_exp_f32 v30, v30
    v_exp_f32 v31, v31
    v_exp_f32 v32, v32
    v_exp_f32 v33, v33
    v_smfmac_f32_32x32x32_bf16 v[48:63], v[140:143], v[24:31], v2
    s_waitcnt lgkmcnt(2)
    v_exp_f32 v34, v34
    v_exp_f32 v35, v35
    v_exp_f32 v36, v36
    v_exp_f32 v37, v37
    v_exp_f32 v38, v38
    v_mfma_f32_32x32x16_bf16 v[16:31], v[120:123], v[112:115], v[80:95]
    s_add_u32 s35, s35, 1
    v_exp_f32 v39, v39
    v_exp_f32 v40, v40
    v_exp_f32 v41, v41
    v_exp_f32 v42, v42
    v_exp_f32 v43, v43
    v_exp_f32 v44, v44
    v_smfmac_f32_32x32x32_bf16 v[64:79], v[136:139], v[32:39], v2
    v_exp_f32 v45, v45
    v_exp_f32 v46, v46
    v_exp_f32 v47, v47
    s_nop 0
    v_exp_f32 v16, v16
    v_exp_f32 v17, v17
    v_smfmac_f32_32x32x32_bf16 v[64:79], v[140:143], v[40:47], v2
    s_waitcnt lgkmcnt(0)
    ds_read_b128 v[124:127], v3 offset:18720
    v_exp_f32 v18, v18
    v_exp_f32 v19, v19
    v_exp_f32 v20, v20
    v_exp_f32 v21, v21
    v_exp_f32 v22, v22
    v_mfma_f32_32x32x16_bf16 v[32:47], v[120:123], v[116:119], v[96:111]
    ds_read_b128 v[136:139], v4 offset:18720
    v_exp_f32 v23, v23
    v_exp_f32 v24, v24
    v_exp_f32 v25, v25
    v_exp_f32 v26, v26
    v_exp_f32 v27, v27
    v_exp_f32 v28, v28
    v_smfmac_f32_32x32x32_bf16 v[48:63], v[128:131], v[16:23], v2
    ds_read_b128 v[140:143], v5 offset:18720
    v_exp_f32 v29, v29
    v_exp_f32 v30, v30
    v_exp_f32 v31, v31
    v_exp_f32 v32, v32
    v_exp_f32 v33, v33
    v_smfmac_f32_32x32x32_bf16 v[48:63], v[132:135], v[24:31], v2
    s_waitcnt lgkmcnt(2)
    v_exp_f32 v34, v34
    v_exp_f32 v35, v35
    v_exp_f32 v36, v36
    v_exp_f32 v37, v37
    v_exp_f32 v38, v38
    v_mfma_f32_32x32x16_bf16 v[16:31], v[124:127], v[112:115], v[80:95]
    v_add_u32 v8, 1, v8
    v_exp_f32 v39, v39
    v_exp_f32 v40, v40
    v_exp_f32 v41, v41
    v_exp_f32 v42, v42
    v_exp_f32 v43, v43
    v_exp_f32 v44, v44
    v_smfmac_f32_32x32x32_bf16 v[64:79], v[128:131], v[32:39], v2
    s_waitcnt vmcnt(0)
    ds_write_b32 v6, v8 offset:33280
    v_exp_f32 v45, v45
    v_exp_f32 v46, v46
    v_exp_f32 v47, v47
    v_exp_f32 v16, v16
    v_exp_f32 v17, v17
    v_smfmac_f32_32x32x32_bf16 v[64:79], v[132:135], v[40:47], v2
    s_waitcnt lgkmcnt(0)
    ds_read_b128 v[120:123], v3 offset:20800
    v_exp_f32 v18, v18
    v_exp_f32 v19, v19
    v_exp_f32 v20, v20
    v_exp_f32 v21, v21
    v_exp_f32 v22, v22
    v_mfma_f32_32x32x16_bf16 v[32:47], v[124:127], v[116:119], v[96:111]
    ds_read_b128 v[128:131], v4 offset:20800
    v_exp_f32 v23, v23
    v_exp_f32 v24, v24
    v_exp_f32 v25, v25
    v_exp_f32 v26, v26
    v_exp_f32 v27, v27
    v_exp_f32 v28, v28
    v_smfmac_f32_32x32x32_bf16 v[48:63], v[136:139], v[16:23], v2
    ds_read_b128 v[132:135], v5 offset:20800
    v_exp_f32 v29, v29
    v_exp_f32 v30, v30
    v_exp_f32 v31, v31
    v_exp_f32 v32, v32
    v_exp_f32 v33, v33
    v_smfmac_f32_32x32x32_bf16 v[48:63], v[140:143], v[24:31], v2
    s_waitcnt lgkmcnt(2)
    v_exp_f32 v34, v34
    v_exp_f32 v35, v35
    v_exp_f32 v36, v36
    v_exp_f32 v37, v37
    v_exp_f32 v38, v38
    v_mfma_f32_32x32x16_bf16 v[16:31], v[120:123], v[112:115], v[80:95]
    v_exp_f32 v39, v39
    v_exp_f32 v40, v40
    v_exp_f32 v41, v41
    v_exp_f32 v42, v42
    v_exp_f32 v43, v43
    v_exp_f32 v44, v44
    v_smfmac_f32_32x32x32_bf16 v[64:79], v[136:139], v[32:39], v2
    v_exp_f32 v45, v45
    v_exp_f32 v46, v46
    v_exp_f32 v47, v47
    s_nop 1
    v_exp_f32 v16, v16
    v_exp_f32 v17, v17
    v_smfmac_f32_32x32x32_bf16 v[64:79], v[140:143], v[40:47], v2
    s_waitcnt lgkmcnt(0)
    ds_read_b128 v[124:127], v3 offset:22880
    v_exp_f32 v18, v18
    v_exp_f32 v19, v19
    v_exp_f32 v20, v20
    v_exp_f32 v21, v21
    v_exp_f32 v22, v22
    v_mfma_f32_32x32x16_bf16 v[32:47], v[120:123], v[116:119], v[96:111]
    ds_read_b128 v[136:139], v4 offset:22880
    v_exp_f32 v23, v23
    v_exp_f32 v24, v24
    v_exp_f32 v25, v25
    v_exp_f32 v26, v26
    v_exp_f32 v27, v27
    v_exp_f32 v28, v28
    v_smfmac_f32_32x32x32_bf16 v[48:63], v[128:131], v[16:23], v2
    ds_read_b128 v[140:143], v5 offset:22880
    v_exp_f32 v29, v29
    v_exp_f32 v30, v30
    v_exp_f32 v31, v31
    v_exp_f32 v32, v32
    v_exp_f32 v33, v33
    v_smfmac_f32_32x32x32_bf16 v[48:63], v[132:135], v[24:31], v2
    s_waitcnt lgkmcnt(2)
    v_exp_f32 v34, v34
    v_exp_f32 v35, v35
    v_exp_f32 v36, v36
    v_exp_f32 v37, v37
    v_exp_f32 v38, v38
    v_mfma_f32_32x32x16_bf16 v[16:31], v[124:127], v[112:115], v[80:95]
    v_exp_f32 v39, v39
    v_exp_f32 v40, v40
    v_exp_f32 v41, v41
    v_exp_f32 v42, v42
    v_exp_f32 v43, v43
    v_exp_f32 v44, v44
    v_smfmac_f32_32x32x32_bf16 v[64:79], v[128:131], v[32:39], v2
    ds_read_b32 v9, v7 offset:33280
    v_exp_f32 v45, v45
    v_exp_f32 v46, v46
    v_exp_f32 v47, v47
    s_nop 0
    v_exp_f32 v16, v16
    v_exp_f32 v17, v17
    v_smfmac_f32_32x32x32_bf16 v[64:79], v[132:135], v[40:47], v2
    s_waitcnt lgkmcnt(0)
    v_cmp_gt_u32 vcc, s35, v9
    s_cbranch_vccnz AT_SPINZ11
AT_BACKZ11:
    ds_read_b128 v[120:123], v3 offset:24960
    v_exp_f32 v18, v18
    v_exp_f32 v19, v19
    v_exp_f32 v20, v20
    v_exp_f32 v21, v21
    v_exp_f32 v22, v22
    v_mfma_f32_32x32x16_bf16 v[32:47], v[124:127], v[116:119], v[96:111]
    ds_read_b128 v[128:131], v4 offset:24960
    v_exp_f32 v23, v23
    v_exp_f32 v24, v24
    v_exp_f32 v25, v25
    v_exp_f32 v26, v26
    v_exp_f32 v27, v27
    v_exp_f32 v28, v28
    v_smfmac_f32_32x32x32_bf16 v[48:63], v[136:139], v[16:23], v2
    ds_read_b128 v[132:135], v5 offset:24960
    v_exp_f32 v29, v29
    v_exp_f32 v30, v30
    v_exp_f32 v31, v31
    v_exp_f32 v32, v32
    v_exp_f32 v33, v33
    v_smfmac_f32_32x32x32_bf16 v[48:63], v[140:143], v[24:31], v2
    s_waitcnt lgkmcnt(2)
    v_exp_f32 v34, v34
    v_exp_f32 v35, v35
    v_exp_f32 v36, v36
    v_exp_f32 v37, v37
    v_exp_f32 v38, v38
    v_mfma_f32_32x32x16_bf16 v[16:31], v[120:123], v[112:115], v[80:95]
    s_add_u32 s35, s35, 1
    v_exp_f32 v39, v39
    v_exp_f32 v40, v40
    v_exp_f32 v41, v41
    v_exp_f32 v42, v42
    v_exp_f32 v43, v43
    v_exp_f32 v44, v44
    v_smfmac_f32_32x32x32_bf16 v[64:79], v[136:139], v[32:39], v2
    v_exp_f32 v45, v45
    v_exp_f32 v46, v46
    v_exp_f32 v47, v47
    s_nop 0
    v_exp_f32 v16, v16
    v_exp_f32 v17, v17
    v_smfmac_f32_32x32x32_bf16 v[64:79], v[140:143], v[40:47], v2
    s_waitcnt lgkmcnt(0)
    ds_read_b128 v[124:127], v3 offset:27040
    v_exp_f32 v18, v18
    v_exp_f32 v19, v19
    v_exp_f32 v20, v20
    v_exp_f32 v21, v21
    v_exp_f32 v22, v22
    v_mfma_f32_32x32x16_bf16 v[32:47], v[120:123], v[116:119], v[96:111]
    ds_read_b128 v[136:139], v4 offset:27040
    v_exp_f32 v23, v23
    v_exp_f32 v24, v24
    v_exp_f32 v25, v25
    v_exp_f32 v26, v26
    v_exp_f32 v27, v27
    v_exp_f32 v28, v28
    v_smfmac_f32_32x32x32_bf16 v[48:63], v[128:131], v[16:23], v2
    ds_read_b128 v[140:143], v5 offset:27040
    v_exp_f32 v29, v29
    v_exp_f32 v30, v30
    v_exp_f32 v31, v31
    v_exp_f32 v32, v32
    v_exp_f32 v33, v33
    v_smfmac_f32_32x32x32_bf16 v[48:63], v[132:135], v[24:31], v2
    s_waitcnt lgkmcnt(2)
    v_exp_f32 v34, v34
    v_exp_f32 v35, v35
    v_exp_f32 v36, v36
    v_exp_f32 v37, v37
    v_exp_f32 v38, v38
    v_mfma_f32_32x32x16_bf16 v[16:31], v[124:127], v[112:115], v[80:95]
    v_add_u32 v8, 1, v8
    v_exp_f32 v39, v39
    v_exp_f32 v40, v40
    v_exp_f32 v41, v41
    v_exp_f32 v42, v42
    v_exp_f32 v43, v43
    v_exp_f32 v44, v44
    v_smfmac_f32_32x32x32_bf16 v[64:79], v[128:131], v[32:39], v2
    ds_write_b32 v6, v8 offset:33280
    v_exp_f32 v45, v45
    v_exp_f32 v46, v46
    v_exp_f32 v47, v47
    v_exp_f32 v16, v16
    v_exp_f32 v17, v17
    v_smfmac_f32_32x32x32_bf16 v[64:79], v[132:135], v[40:47], v2
    s_waitcnt lgkmcnt(0)
    ds_read_b128 v[120:123], v3 offset:29120
    v_exp_f32 v18, v18
    v_exp_f32 v19, v19
    v_exp_f32 v20, v20
    v_exp_f32 v21, v21
    v_exp_f32 v22, v22
    v_mfma_f32_32x32x16_bf16 v[32:47], v[124:127], v[116:119], v[96:111]
    ds_read_b128 v[128:131], v4 offset:29120
    v_exp_f32 v23, v23
    v_exp_f32 v24, v24
    v_exp_f32 v25, v25
    v_exp_f32 v26, v26
    v_exp_f32 v27, v27
    v_exp_f32 v28, v28
    v_smfmac_f32_32x32x32_bf16 v[48:63], v[136:139], v[16:23], v2
    ds_read_b128 v[132:135], v5 offset:29120
    v_exp_f32 v29, v29
    v_exp_f32 v30, v30
    v_exp_f32 v31, v31
    v_exp_f32 v32, v32
    v_exp_f32 v33, v33
    v_smfmac_f32_32x32x32_bf16 v[48:63], v[140:143], v[24:31], v2
    s_waitcnt lgkmcnt(2)
    v_exp_f32 v34, v34
    v_exp_f32 v35, v35
    v_exp_f32 v36, v36
    v_exp_f32 v37, v37
    v_exp_f32 v38, v38
    v_mfma_f32_32x32x16_bf16 v[16:31], v[120:123], v[112:115], v[80:95]
    v_exp_f32 v39, v39
    v_exp_f32 v40, v40
    v_exp_f32 v41, v41
    v_exp_f32 v42, v42
    v_exp_f32 v43, v43
    v_exp_f32 v44, v44
    v_smfmac_f32_32x32x32_bf16 v[64:79], v[136:139], v[32:39], v2
    v_exp_f32 v45, v45
    v_exp_f32 v46, v46
    v_exp_f32 v47, v47
    s_nop 1
    v_exp_f32 v16, v16
    v_exp_f32 v17, v17
    v_smfmac_f32_32x32x32_bf16 v[64:79], v[140:143], v[40:47], v2
    s_waitcnt lgkmcnt(0)
    ds_read_b128 v[124:127], v3 offset:31200
    v_exp_f32 v18, v18
    v_exp_f32 v19, v19
    v_exp_f32 v20, v20
    v_exp_f32 v21, v21
    v_exp_f32 v22, v22
    v_mfma_f32_32x32x16_bf16 v[32:47], v[120:123], v[116:119], v[96:111]
    ds_read_b128 v[136:139], v4 offset:31200
    s_mov_b64 exec, 1
    buffer_atomic_add v15, v14, s[12:15], s53 offen sc1
    s_mov_b64 exec, -1
    v_exp_f32 v23, v23
    v_exp_f32 v24, v24
    v_exp_f32 v25, v25
    v_exp_f32 v26, v26
    v_exp_f32 v27, v27
    v_exp_f32 v28, v28
    v_smfmac_f32_32x32x32_bf16 v[48:63], v[128:131], v[16:23], v2
    ds_read_b128 v[140:143], v5 offset:31200
    v_exp_f32 v29, v29
    v_exp_f32 v30, v30
    v_exp_f32 v31, v31
    v_exp_f32 v32, v32
    v_exp_f32 v33, v33
    v_smfmac_f32_32x32x32_bf16 v[48:63], v[132:135], v[24:31], v2
    s_waitcnt lgkmcnt(2)
    v_exp_f32 v34, v34
    v_exp_f32 v35, v35
    v_exp_f32 v36, v36
    v_exp_f32 v37, v37
    v_exp_f32 v38, v38
    v_mfma_f32_32x32x16_bf16 v[16:31], v[124:127], v[112:115], v[80:95]
    v_exp_f32 v39, v39
    v_exp_f32 v40, v40
    v_exp_f32 v41, v41
    v_exp_f32 v42, v42
    v_exp_f32 v43, v43
    v_exp_f32 v44, v44
    v_smfmac_f32_32x32x32_bf16 v[64:79], v[128:131], v[32:39], v2
    v_exp_f32 v45, v45
    v_exp_f32 v46, v46
    v_exp_f32 v47, v47
    s_nop 1
    v_exp_f32 v16, v16
    v_exp_f32 v17, v17
    v_smfmac_f32_32x32x32_bf16 v[64:79], v[132:135], v[40:47], v2
    s_waitcnt lgkmcnt(0)
    v_exp_f32 v18, v18
    v_exp_f32 v19, v19
    v_exp_f32 v20, v20
    v_exp_f32 v21, v21
    v_exp_f32 v22, v22
    v_mfma_f32_32x32x16_bf16 v[32:47], v[124:127], v[116:119], v[96:111]
    v_exp_f32 v23, v23
    v_exp_f32 v24, v24
    v_exp_f32 v25, v25
    v_exp_f32 v26, v26
    v_exp_f32 v27, v27
    v_exp_f32 v28, v28
    v_smfmac_f32_32x32x32_bf16 v[48:63], v[136:139], v[16:23], v2
    v_exp_f32 v29, v29
    v_exp_f32 v30, v30
    v_exp_f32 v31, v31
    s_nop 1
    v_exp_f32 v32, v32
    v_exp_f32 v33, v33
    v_smfmac_f32_32x32x32_bf16 v[48:63], v[140:143], v[24:31], v2
    v_exp_f32 v34, v34
    v_exp_f32 v35, v35
    v_exp_f32 v36, v36
    v_exp_f32 v37, v37
    v_exp_f32 v38, v38
    v_exp_f32 v39, v39
    v_exp_f32 v40, v40
    v_exp_f32 v41, v41
    v_exp_f32 v42, v42
    v_exp_f32 v43, v43
    v_exp_f32 v44, v44
    v_smfmac_f32_32x32x32_bf16 v[64:79], v[136:139], v[32:39], v2
    v_exp_f32 v45, v45
    v_exp_f32 v46, v46
    v_exp_f32 v47, v47
    s_nop 0
    s_nop 0
    v_smfmac_f32_32x32x32_bf16 v[64:79], v[140:143], v[40:47], v2
    v_add_u32 v8, 1, v8
    ds_write_b32 v6, v8 offset:33280
AT_FIN:
    s_nop 7
    v_max3_f32 v10, abs(v48), abs(v49), v56
    v_max3_f32 v10, abs(v50), abs(v51), v10
    v_max3_f32 v10, abs(v52), abs(v53), v10
    v_max3_f32 v10, abs(v54), abs(v55), v10
    v_max3_f32 v11, abs(v64), abs(v65), v72
    v_max3_f32 v11, abs(v66), abs(v67), v11
    v_max3_f32 v11, abs(v68), abs(v69), v11
    v_max3_f32 v11, abs(v70), abs(v71), v11
    v_max_f32 v10, v10, v11
    v_cmp_nlt_f32 vcc, v10, v13
    s_cmp_eq_u32 s36, 0
    s_cselect_b64 vcc, vcc, 0
    s_cbranch_vccnz AT_SLOW
    s_mov_b64 exec, 1
    v_cmp_gt_u32 vcc, 16, v12
    s_cbranch_vccnz AT_S1W
AT_S1X:
    s_mov_b64 exec, -1
    v_rcp_f32 v10, v56
    v_rcp_f32 v11, v72
    s_lshl_b32 s31, s29, 10
    s_lshl_b32 s32, s30, 18
    s_add_u32 s31, s31, s32
    s_lshl_b32 s32, s28, 16
    s_add_u32 s31, s31, s32
    s_add_u32 s31, s31, 0xa00000
    s_add_u32 s32, s31, 0x8000
    v_mul_f32 v48, v48, v10
    v_mul_f32 v49, v49, v10
    v_mul_f32 v50, v50, v10
    v_mul_f32 v51, v51, v10
    v_mul_f32 v52, v52, v10
    v_mul_f32 v53, v53, v10
    v_mul_f32 v54, v54, v10
    v_mul_f32 v55, v55, v10
    v_cvt_pk_bf16_f32 v48, v48, v49
    v_cvt_pk_bf16_f32 v49, v50, v51
    v_cvt_pk_bf16_f32 v50, v52, v53
    v_cvt_pk_bf16_f32 v51, v54, v55
    buffer_store_dwordx4 v[48:51], v3, s[12:15], s31 offen sc1
    v_mul_f32 v64, v64, v11
    v_mul_f32 v65, v65, v11
    v_mul_f32 v66, v66, v11
    v_mul_f32 v67, v67, v11
    v_mul_f32 v68, v68, v11
    v_mul_f32 v69, v69, v11
    v_mul_f32 v70, v70, v11
    v_mul_f32 v71, v71, v11
    v_cvt_pk_bf16_f32 v64, v64, v65
    v_cvt_pk_bf16_f32 v65, v66, v67
    v_cvt_pk_bf16_f32 v66, v68, v69
    v_cvt_pk_bf16_f32 v67, v70, v71
    buffer_store_dwordx4 v[64:67], v3, s[12:15], s32 offen sc1
    s_endpgm
AT_SPIN3:
    s_mov_b32 s31, 400000
AT_SPINL3:
    ds_read_b32 v9, v7 offset:33280
    s_sub_u32 s31, s31, 1
    s_cmp_eq_u32 s31, 0
    s_cbranch_scc1 AT_BACK3
    s_waitcnt lgkmcnt(0)
    v_cmp_gt_u32 vcc, s35, v9
    s_cbranch_vccnz AT_SPINL3
    s_branch AT_BACK3
AT_SPIN7:
    s_mov_b32 s31, 400000
AT_SPINL7:
    ds_read_b32 v9, v7 offset:33280
    s_sub_u32 s31, s31, 1
    s_cmp_eq_u32 s31, 0
    s_cbranch_scc1 AT_BACK7
    s_waitcnt lgkmcnt(0)
    v_cmp_gt_u32 vcc, s35, v9
    s_cbranch_vccnz AT_SPINL7
    s_branch AT_BACK7
AT_SPIN11:
    s_mov_b32 s31, 400000
AT_SPINL11:
    ds_read_b32 v9, v7 offset:33280
    s_sub_u32 s31, s31, 1
    s_cmp_eq_u32 s31, 0
    s_cbranch_scc1 AT_BACK11
    s_waitcnt lgkmcnt(0)
    v_cmp_gt_u32 vcc, s35, v9
    s_cbranch_vccnz AT_SPINL11
    s_branch AT_BACK11
AT_SPIN15:
    s_mov_b32 s31, 400000
AT_SPINL15:
    ds_read_b32 v9, v7 offset:33280
    s_sub_u32 s31, s31, 1
    s_cmp_eq_u32 s31, 0
    s_cbranch_scc1 AT_BACK15
    s_waitcnt lgkmcnt(0)
    v_cmp_gt_u32 vcc, s35, v9
    s_cbranch_vccnz AT_SPINL15
    s_branch AT_BACK15
AT_SPINZ3:
    s_mov_b32 s31, 400000
AT_SPINLZ3:
    ds_read_b32 v9, v7 offset:33280
    s_sub_u32 s31, s31, 1
    s_cmp_eq_u32 s31, 0
    s_cbranch_scc1 AT_BACKZ3
    s_waitcnt lgkmcnt(0)
    v_cmp_gt_u32 vcc, s35, v9
    s_cbranch_vccnz AT_SPINLZ3
    s_branch AT_BACKZ3
AT_SPINZ7:
    s_mov_b32 s31, 400000
AT_SPINLZ7:
    ds_read_b32 v9, v7 offset:33280
    s_sub_u32 s31, s31, 1
    s_cmp_eq_u32 s31, 0
    s_cbranch_scc1 AT_BACKZ7
    s_waitcnt lgkmcnt(0)
    v_cmp_gt_u32 vcc, s35, v9
    s_cbranch_vccnz AT_SPINLZ7
    s_branch AT_BACKZ7
AT_SPINZ11:
    s_mov_b32 s31, 400000
AT_SPINLZ11:
    ds_read_b32 v9, v7 offset:33280
    s_sub_u32 s31, s31, 1
    s_cmp_eq_u32 s31, 0
    s_cbranch_scc1 AT_BACKZ11
    s_waitcnt lgkmcnt(0)
    v_cmp_gt_u32 vcc, s35, v9
    s_cbranch_vccnz AT_SPINLZ11
    s_branch AT_BACKZ11
AT_S1W:
    s_mov_b32 s31, 400000
AT_S1L:
    buffer_atomic_umax v12, v14, s[12:15], s52 offen sc0 sc1
    s_sub_u32 s31, s31, 1
    s_cmp_eq_u32 s31, 0
    s_cbranch_scc1 AT_S1X
    s_waitcnt vmcnt(0)
    v_cmp_gt_u32 vcc, 16, v12
    s_cbranch_vccz AT_S1X
    s_sleep 8
    s_branch AT_S1L
AT_SLOW:
    s_mov_b32 s36, 1
    s_mov_b32 s10, 0x20000
    s_mov_b32 s33, 0
    v_mov_b32 v80, 0xff800000
    v_mov_b32 v96, 0xff800000
    s_waitcnt vmcnt(0) lgkmcnt(0)
AT_SLOW1:
    buffer_load_dwordx4 v[120:123], v3, s[8:11], s33 offen sc1
    s_add_u32 s33, s33, 2048
    s_waitcnt vmcnt(0)
    v_mfma_f32_32x32x16_bf16 v[16:31], v[120:123], v[112:115], 0
    v_mfma_f32_32x32x16_bf16 v[32:47], v[120:123], v[116:119], 0
    s_nop 10
    v_max3_f32 v80, v80, v16, v17
    v_max_f32 v80, v80, v18
    v_max3_f32 v80, v80, v19, v20
    v_max3_f32 v80, v80, v21, v22
    v_max3_f32 v80, v80, v23, v24
    v_max3_f32 v80, v80, v25, v26
    v_max3_f32 v80, v80, v27, v28
    v_max3_f32 v80, v80, v29, v30
    v_max_f32 v80, v80, v31
    v_max3_f32 v96, v96, v32, v33
    v_max_f32 v96, v96, v34
    v_max3_f32 v96, v96, v35, v36
    v_max3_f32 v96, v96, v37, v38
    v_max3_f32 v96, v96, v39, v40
    v_max3_f32 v96, v96, v41, v42
    v_max3_f32 v96, v96, v43, v44
    v_max3_f32 v96, v96, v45, v46
    v_max_f32 v96, v96, v47
    s_cmp_lt_u32 s33, 0x20000
    s_cbranch_scc1 AT_SLOW1
    v_mov_b32 v10, v80
    s_nop 1
    v_permlane32_swap_b32 v80, v10
    v_max_f32 v10, v80, v10
    v_sub_f32 v80, 0, v10
    v_sub_f32 v81, 0, v10
    v_sub_f32 v82, 0, v10
    v_sub_f32 v83, 0, v10
    v_sub_f32 v84, 0, v10
    v_sub_f32 v85, 0, v10
    v_sub_f32 v86, 0, v10
    v_sub_f32 v87, 0, v10
    v_sub_f32 v88, 0, v10
    v_sub_f32 v89, 0, v10
    v_sub_f32 v90, 0, v10
    v_sub_f32 v91, 0, v10
    v_sub_f32 v92, 0, v10
    v_sub_f32 v93, 0, v10
    v_sub_f32 v94, 0, v10
    v_sub_f32 v95, 0, v10
    v_mov_b32 v11, v96
    s_nop 1
    v_permlane32_swap_b32 v96, v11
    v_max_f32 v11, v96, v11
    v_sub_f32 v96, 0, v11
    v_sub_f32 v97, 0, v11
    v_sub_f32 v98, 0, v11
    v_sub_f32 v99, 0, v11
    v_sub_f32 v100, 0, v11
    v_sub_f32 v101, 0, v11
    v_sub_f32 v102, 0, v11
    v_sub_f32 v103, 0, v11
    v_sub_f32 v104, 0, v11
    v_sub_f32 v105, 0, v11
    v_sub_f32 v106, 0, v11
    v_sub_f32 v107, 0, v11
    v_sub_f32 v108, 0, v11
    v_sub_f32 v109, 0, v11
    v_sub_f32 v110, 0, v11
    v_sub_f32 v111, 0, v11
    v_mov_b32 v48, 0
    v_mov_b32 v64, 0
    v_mov_b32 v49, 0
    v_mov_b32 v65, 0
    v_mov_b32 v50, 0
    v_mov_b32 v66, 0
    v_mov_b32 v51, 0
    v_mov_b32 v67, 0
    v_mov_b32 v52, 0
    v_mov_b32 v68, 0
    v_mov_b32 v53, 0
    v_mov_b32 v69, 0
    v_mov_b32 v54, 0
    v_mov_b32 v70, 0
    v_mov_b32 v55, 0
    v_mov_b32 v71, 0
    v_mov_b32 v56, 0
    v_mov_b32 v72, 0
    v_mov_b32 v128, 0x3f803f80
    v_mov_b32 v129, 0x3f803f80
    v_mov_b32 v130, 0x3f803f80
    v_mov_b32 v131, 0x3f803f80
    v_mov_b32 v132, 0x3f803f80
    v_mov_b32 v133, 0x3f803f80
    v_mov_b32 v134, 0x3f803f80
    v_mov_b32 v135, 0x3f803f80
    s_mov_b32 s33, 0
    s_mov_b32 s38, 0xffff
    s_mov_b32 s39, 0xffff
AT_SLOW2:
    buffer_load_dwordx4 v[120:123], v3, s[8:11], s33 offen sc1
    s_mov_b64 exec, s[38:39]
    buffer_load_dwordx4 v[128:131], v4, s[8:11], s33 offen sc1
    buffer_load_dwordx4 v[132:135], v5, s[8:11], s33 offen sc1
    s_mov_b64 exec, -1
    s_add_u32 s33, s33, 2048
    s_waitcnt vmcnt(0)
    v_mfma_f32_32x32x16_bf16 v[16:31], v[120:123], v[112:115], v[80:95]
    v_mfma_f32_32x32x16_bf16 v[32:47], v[120:123], v[116:119], v[96:111]
    s_nop 10
    v_exp_f32 v16, v16
    v_exp_f32 v17, v17
    v_exp_f32 v18, v18
    v_exp_f32 v19, v19
    v_exp_f32 v20, v20
    v_exp_f32 v21, v21
    v_exp_f32 v22, v22
    v_exp_f32 v23, v23
    v_exp_f32 v24, v24
    v_exp_f32 v25, v25
    v_exp_f32 v26, v26
    v_exp_f32 v27, v27
    v_exp_f32 v28, v28
    v_exp_f32 v29, v29
    v_exp_f32 v30, v30
    v_exp_f32 v31, v31
    v_exp_f32 v32, v32
    v_exp_f32 v33, v33
    v_exp_f32 v34, v34
    v_exp_f32 v35, v35
    v_exp_f32 v36, v36
    v_exp_f32 v37, v37
    v_exp_f32 v38, v38
    v_exp_f32 v39, v39
    v_exp_f32 v40, v40
    v_exp_f32 v41, v41
    v_exp_f32 v42, v42
    v_exp_f32 v43, v43
    v_exp_f32 v44, v44
    v_exp_f32 v45, v45
    v_exp_f32 v46, v46
    v_exp_f32 v47, v47
    v_smfmac_f32_32x32x32_bf16 v[48:63], v[128:131], v[16:23], v2
    v_smfmac_f32_32x32x32_bf16 v[48:63], v[132:135], v[24:31], v2
    v_smfmac_f32_32x32x32_bf16 v[64:79], v[128:131], v[32:39], v2
    v_smfmac_f32_32x32x32_bf16 v[64:79], v[132:135], v[40:47], v2
    s_cmp_lt_u32 s33, 0x20000
    s_cbranch_scc1 AT_SLOW2
    s_nop 3
    s_branch AT_FIN
.p2align 6
K2_CHAIN:
    s_sub_u32 s29, s28, 4
    s_lshl_b32 s34, s29, 8
    v_lshl_add_u32 v9, v1, 2, s34
    v_mov_b32 v11, 0
    v_mov_b32 v25, 0
    s_and_b32 s34, s2, 7
    s_lshl_b32 s30, s34, 1
    s_bfe_u32 s35, s2, 0x10003
    s_add_u32 s30, s30, s35
    s_lshr_b32 s31, s2, 4
    s_and_b32 s34, s31, 1
    s_lshl_b32 s32, s30, 1
    s_add_u32 s32, s32, s34
    s_lshr_b32 s33, s31, 1
    s_and_b32 s48, s29, 1
    s_lshr_b32 s49, s29, 1
    s_lshl_b32 s54, s32, 1
    s_add_u32 s54, s54, s49
    v_and_b32 v2, 31, v1
    v_lshrrev_b32 v3, 5, v1
    v_lshlrev_b32 v28, 4, v1
    s_lshl_b32 s34, s33, 1
    s_add_u32 s34, s34, s48
    s_lshl_b32 s34, s34, 10
    v_add_u32 v16, s34, v28
    v_xor_b32 v17, 1024, v16
    s_add_u32 s34, s49, 1
    s_sub_u32 s35, 0, s34
    s_cmp_eq_u32 s48, 0
    s_cselect_b32 s34, s35, s34
    s_lshl_b32 s36, s54, 5
    v_add_u32 v15, s36, v2
    v_mov_b32 v7, 0x40000000
    v_xor_b32 v4, 0, v15
    v_add_u32 v4, s34, v4
    v_cmp_gt_u32 vcc, 0x800, v4
    v_lshrrev_b32 v5, 5, v4
    v_and_b32 v4, 31, v4
    v_lshlrev_b32 v4, 4, v4
    v_lshl_add_u32 v4, v5, 15, v4
    v_lshl_add_u32 v4, v3, 9, v4
    v_cndmask_b32 v21, v7, v4, vcc
    v_xor_b32 v4, 32, v15
    v_add_u32 v4, s34, v4
    v_cmp_gt_u32 vcc, 0x800, v4
    v_lshrrev_b32 v5, 5, v4
    v_and_b32 v4, 31, v4
    v_lshlrev_b32 v4, 4, v4
    v_lshl_add_u32 v4, v5, 15, v4
    v_lshl_add_u32 v4, v3, 9, v4
    v_cndmask_b32 v22, v7, v4, vcc
    s_and_b32 s34, s32, 3
    s_lshl_b32 s56, s34, 1
    s_add_u32 s56, s56, s33
    s_mov_b32 s50, s56
    s_lshl_b32 s52, s29, 3
    s_waitcnt lgkmcnt(0)
    s_mov_b32 s40, s26
    s_mov_b32 s41, s27
    s_mov_b32 s42, 0x1c00000
    s_mov_b32 s43, 0x20000
    s_add_u32 s8, s26, 0x600000
    s_addc_u32 s9, s27, 0
    s_mov_b32 s10, 0x200000
    s_mov_b32 s11, 0x20000
    s_mov_b32 s12, s16
    s_mov_b32 s13, s17
    s_mov_b32 s14, 0x200000
    s_mov_b32 s15, 0x20000
    s_mov_b32 s44, s18
    s_mov_b32 s45, s19
    s_mov_b32 s46, 0x200000
    s_mov_b32 s47, 0x20000
    v_lshlrev_b32 v23, 10, v15
    v_lshl_add_u32 v23, v3, 4, v23
    s_lshl_b32 s34, s33, 7
    s_lshl_b32 s35, s48, 6
    s_add_u32 s34, s34, s35
    v_add_u32 v23, s34, v23
    v_lshlrev_b32 v24, 3, v15
    v_add_u32 v26, 36864, v28
    v_add_u32 v27, 86016, v28
    s_mul_i32 s34, s29, 12288
    s_add_u32 s34, s34, 110592
    v_add_u32 v14, s34, v28
    s_xor_b32 s34, s29, 1
    s_mul_i32 s34, s34, 12288
    s_add_u32 s34, s34, 110592
    v_add_u32 v18, s34, v28
    s_xor_b32 s34, s29, 2
    s_mul_i32 s34, s34, 12288
    s_add_u32 s34, s34, 114688
    v_add_u32 v19, s34, v28
    s_xor_b32 s34, s29, 3
    s_mul_i32 s34, s34, 12288
    s_add_u32 s34, s34, 118784
    v_add_u32 v20, s34, v28
    v_and_b32 v10, 3, v1
    v_lshlrev_b32 v10, 8, v10
    v_lshl_add_u32 v10, v1, 2, v10
    s_lshl_b32 s38, s30, 10
    s_add_u32 s38, s38, 0x1b18000
    s_and_b32 s57, s31, 3
    s_lshl_b32 s57, s57, 8
    s_add_u32 s57, s57, s38
    s_mov_b32 s39, 0
    s_and_b32 s34, s30, 1
    s_lshl_b32 s34, s34, 2
    s_lshl_b32 s51, s31, 1
    s_add_u32 s51, s51, s34
    s_mul_i32 s55, s31, 3072
    s_add_u32 s55, s55, 0x1800000
    s_cmp_eq_u32 s31, 15
    s_cmov_b32 s55, 0x40000000
    s_lshl_b32 s34, s32, 6
    s_add_u32 s35, s34, 65
    s_min_u32 s35, s35, 2047
    s_max_u32 s34, s34, 2
    s_sub_u32 s34, s34, 2
    s_lshr_b32 s34, s34, 7
    s_lshr_b32 s35, s35, 7
    s_add_u32 s34, s34, 56
    s_add_u32 s35, s35, 56
    s_add_u32 s36, s33, 96
    v_mov_b32 v6, s34
    v_mov_b32 v7, 4
    v_writelane_b32 v6, s35, 1
    v_writelane_b32 v7, 8, 0
    v_writelane_b32 v6, s36, 2
    s_mul_i32 s34, s31, 3
    s_add_u32 s35, s34, 2
    s_lshr_b32 s34, s34, 1
    s_lshr_b32 s35, s35, 1
    s_min_u32 s34, s34, 21
    s_min_u32 s35, s35, 21
    s_add_u32 s34, s34, 72
    s_add_u32 s35, s35, 72
    v_writelane_b32 v7, 8, 1
    v_writelane_b32 v6, s34, 3
    s_add_u32 s34, s33, 104
    v_writelane_b32 v6, s35, 4
    s_add_u32 s35, s33, 112
    v_writelane_b32 v7, 11, 6
    v_writelane_b32 v6, s34, 5
    s_nop 0
    v_writelane_b32 v6, s35, 6
    s_mov_b32 s35, 0x1b00000
    v_lshlrev_b32 v6, 8, v6
    s_cmp_lg_u32 s29, 0
    s_cbranch_scc1 CH_Q0
    s_mov_b32 s34, 400000
    v_mov_b32 v12, 0
    s_mov_b64 exec, 127
CH_P0:
    buffer_atomic_umax v12, v6, s[40:43], s35 offen sc0 sc1
    s_sub_u32 s34, s34, 1
    s_cmp_eq_u32 s34, 0
    s_cbranch_scc1 CH_Q0
    s_waitcnt vmcnt(0)
    v_cmp_gt_u32 vcc, v7, v12
    s_cbranch_vccz CH_Q0
    s_sleep 4
    s_branch CH_P0
CH_Q0:
    s_mov_b64 exec, -1
    s_waitcnt vmcnt(0)
    v_add_u32 v11, 1, v11
    s_add_u32 s39, s39, 1
    s_waitcnt lgkmcnt(0)
    ds_write_b32 v9, v11 offset:34304
    s_mov_b32 s34, 400000
CH_W1:
    ds_read_b32 v12, v10 offset:34304
    s_sub_u32 s34, s34, 1
    s_cmp_eq_u32 s34, 0
    s_cbranch_scc1 CH_X1
    s_waitcnt lgkmcnt(0)
    v_cmp_gt_u32 vcc, s39, v12
    s_cbranch_vccz CH_X1
    s_sleep 2
    s_branch CH_W1
CH_X1:
    s_waitcnt lgkmcnt(0)
    s_mov_b32 s34, 400000
CH_W2:
    ds_read_b32 v12, v25 offset:35336
    s_sub_u32 s34, s34, 1
    s_cmp_eq_u32 s34, 0
    s_cbranch_scc1 CH_X2
    s_waitcnt lgkmcnt(0)
    v_cmp_gt_u32 vcc, 1, v12
    s_cbranch_vccnz CH_W2
CH_X2:
    s_waitcnt lgkmcnt(0)
    s_and_b32 s50, s50, 7
    s_add_u32 s34, s50, s52
    s_add_u32 s50, s50, 1
    s_lshl_b32 s35, s34, 10
    s_lshl_b32 s37, s34, 14
    s_add_u32 s37, s37, 0x1700000
    buffer_load_dwordx4 v[120:123], v16, s[40:43], s37 offen sc1
    buffer_load_dwordx4 v[124:127], v17, s[40:43], s37 offen sc1
    buffer_load_dwordx4 v[128:131], v21, s[8:11], s35 offen sc1
    buffer_load_dwordx4 v[132:135], v22, s[8:11], s35 offen sc1
    s_and_b32 s50, s50, 7
    s_add_u32 s34, s50, s52
    s_add_u32 s50, s50, 1
    s_lshl_b32 s35, s34, 10
    s_lshl_b32 s37, s34, 14
    s_add_u32 s37, s37, 0x1700000
    buffer_load_dwordx4 v[136:139], v16, s[40:43], s37 offen sc1
    buffer_load_dwordx4 v[140:143], v17, s[40:43], s37 offen sc1
    buffer_load_dwordx4 v[144:147], v21, s[8:11], s35 offen sc1
    buffer_load_dwordx4 v[148:151], v22, s[8:11], s35 offen sc1
    s_and_b32 s50, s50, 7
    s_add_u32 s34, s50, s52
    s_add_u32 s50, s50, 1
    s_lshl_b32 s35, s34, 10
    s_lshl_b32 s37, s34, 14
    s_add_u32 s37, s37, 0x1700000
    buffer_load_dwordx4 v[152:155], v16, s[40:43], s37 offen sc1
    buffer_load_dwordx4 v[156:159], v17, s[40:43], s37 offen sc1
    buffer_load_dwordx4 v[160:163], v21, s[8:11], s35 offen sc1
    buffer_load_dwordx4 v[164:167], v22, s[8:11], s35 offen sc1
    s_and_b32 s50, s50, 7
    s_add_u32 s34, s50, s52
    s_add_u32 s50, s50, 1
    s_lshl_b32 s35, s34, 10
    s_lshl_b32 s37, s34, 14
    s_add_u32 s37, s37, 0x1700000
    buffer_load_dwordx4 v[168:171], v16, s[40:43], s37 offen sc1
    buffer_load_dwordx4 v[172:175], v17, s[40:43], s37 offen sc1
    buffer_load_dwordx4 v[176:179], v21, s[8:11], s35 offen sc1
    buffer_load_dwordx4 v[180:183], v22, s[8:11], s35 offen sc1
    s_and_b32 s50, s50, 7
    s_add_u32 s34, s50, s52
    s_add_u32 s50, s50, 1
    s_lshl_b32 s35, s34, 10
    s_lshl_b32 s37, s34, 14
    s_add_u32 s37, s37, 0x1700000
    buffer_load_dwordx4 v[184:187], v16, s[40:43], s37 offen sc1
    buffer_load_dwordx4 v[188:191], v17, s[40:43], s37 offen sc1
    buffer_load_dwordx4 v[192:195], v21, s[8:11], s35 offen sc1
    buffer_load_dwordx4 v[196:199], v22, s[8:11], s35 offen sc1
    s_waitcnt vmcnt(16)
    v_mfma_f32_32x32x16_bf16 v[48:63], v[124:127], v[128:131], 0
    v_mfma_f32_32x32x16_bf16 v[64:79], v[120:123], v[132:135], 0
    v_mfma_f32_32x32x16_bf16 v[80:95], v[124:127], v[132:135], 0
    v_mfma_f32_32x32x16_bf16 v[32:47], v[120:123], v[128:131], 0
    s_and_b32 s50, s50, 7
    s_add_u32 s34, s50, s52
    s_add_u32 s50, s50, 1
    s_lshl_b32 s35, s34, 10
    s_lshl_b32 s37, s34, 14
    s_add_u32 s37, s37, 0x1700000
    buffer_load_dwordx4 v[200:203], v16, s[40:43], s37 offen sc1
    buffer_load_dwordx4 v[204:207], v17, s[40:43], s37 offen sc1
    buffer_load_dwordx4 v[208:211], v21, s[8:11], s35 offen sc1
    buffer_load_dwordx4 v[212:215], v22, s[8:11], s35 offen sc1
    s_waitcnt vmcnt(16)
    v_mfma_f32_32x32x16_bf16 v[48:63], v[140:143], v[144:147], v[48:63]
    v_mfma_f32_32x32x16_bf16 v[64:79], v[136:139], v[148:151], v[64:79]
    v_mfma_f32_32x32x16_bf16 v[80:95], v[140:143], v[148:151], v[80:95]
    v_mfma_f32_32x32x16_bf16 v[32:47], v[136:139], v[144:147], v[32:47]
    s_and_b32 s50, s50, 7
    s_add_u32 s34, s50, s52
    s_add_u32 s50, s50, 1
    s_lshl_b32 s35, s34, 10
    s_lshl_b32 s37, s34, 14
    s_add_u32 s37, s37, 0x1700000
    buffer_load_dwordx4 v[216:219], v16, s[40:43], s37 offen sc1
    buffer_load_dwordx4 v[220:223], v17, s[40:43], s37 offen sc1
    buffer_load_dwordx4 v[224:227], v21, s[8:11], s35 offen sc1
    buffer_load_dwordx4 v[228:231], v22, s[8:11], s35 offen sc1
    s_waitcnt vmcnt(16)
    v_mfma_f32_32x32x16_bf16 v[48:63], v[156:159], v[160:163], v[48:63]
    v_mfma_f32_32x32x16_bf16 v[64:79], v[152:155], v[164:167], v[64:79]
    v_mfma_f32_32x32x16_bf16 v[80:95], v[156:159], v[164:167], v[80:95]
    v_mfma_f32_32x32x16_bf16 v[32:47], v[152:155], v[160:163], v[32:47]
    s_and_b32 s50, s50, 7
    s_add_u32 s34, s50, s52
    s_add_u32 s50, s50, 1
    s_lshl_b32 s35, s34, 10
    s_lshl_b32 s37, s34, 14
    s_add_u32 s37, s37, 0x1700000
    buffer_load_dwordx4 v[232:235], v16, s[40:43], s37 offen sc1
    buffer_load_dwordx4 v[236:239], v17, s[40:43], s37 offen sc1
    buffer_load_dwordx4 v[240:243], v21, s[8:11], s35 offen sc1
    buffer_load_dwordx4 v[244:247], v22, s[8:11], s35 offen sc1
    s_waitcnt vmcnt(16)
    v_mfma_f32_32x32x16_bf16 v[48:63], v[172:175], v[176:179], v[48:63]
    v_mfma_f32_32x32x16_bf16 v[64:79], v[168:171], v[180:183], v[64:79]
    v_mfma_f32_32x32x16_bf16 v[80:95], v[172:175], v[180:183], v[80:95]
    v_mfma_f32_32x32x16_bf16 v[32:47], v[168:171], v[176:179], v[32:47]
    s_mov_b32 s35, 0x1600000
    buffer_load_dwordx4 v[96:99], v23, s[12:15], 0 offen
    buffer_load_dwordx4 v[100:103], v23, s[12:15], 0 offen offset:32
    buffer_load_dwordx2 v[252:253], v24, s[40:43], s35 offen sc1
    s_mul_i32 s34, s31, 384
    s_add_u32 s34, s34, 0x1668000
    v_lshlrev_b32 v6, 3, v1
    buffer_load_dwordx2 v[104:105], v6, s[40:43], s34 offen sc1
    s_add_u32 s34, s34, 6144
    buffer_load_dwordx2 v[106:107], v6, s[40:43], s34 offen sc1
    s_add_u32 s34, s34, 6144
    buffer_load_dwordx2 v[108:109], v6, s[40:43], s34 offen sc1
    s_add_u32 s34, s34, 6144
    buffer_load_dwordx2 v[110:111], v6, s[40:43], s34 offen sc1
    s_waitcnt vmcnt(19)
    v_mfma_f32_32x32x16_bf16 v[48:63], v[188:191], v[192:195], v[48:63]
    v_mfma_f32_32x32x16_bf16 v[64:79], v[184:187], v[196:199], v[64:79]
    v_mfma_f32_32x32x16_bf16 v[80:95], v[188:191], v[196:199], v[80:95]
    v_mfma_f32_32x32x16_bf16 v[32:47], v[184:187], v[192:195], v[32:47]
    s_waitcnt vmcnt(15)
    v_mfma_f32_32x32x16_bf16 v[48:63], v[204:207], v[208:211], v[48:63]
    v_mfma_f32_32x32x16_bf16 v[64:79], v[200:203], v[212:215], v[64:79]
    v_mfma_f32_32x32x16_bf16 v[80:95], v[204:207], v[212:215], v[80:95]
    v_mfma_f32_32x32x16_bf16 v[32:47], v[200:203], v[208:211], v[32:47]
    s_waitcnt vmcnt(11)
    v_mfma_f32_32x32x16_bf16 v[48:63], v[220:223], v[224:227], v[48:63]
    v_mfma_f32_32x32x16_bf16 v[64:79], v[216:219], v[228:231], v[64:79]
    v_mfma_f32_32x32x16_bf16 v[80:95], v[220:223], v[228:231], v[80:95]
    v_mfma_f32_32x32x16_bf16 v[32:47], v[216:219], v[224:227], v[32:47]
    s_mul_i32 s34, s29, 6
    s_add_u32 s34, s34, 0
    s_add_u32 s35, s34, s51
    s_and_b32 s35, s35, 31
    s_mul_i32 s34, s34, 3072
    s_add_u32 m0, s34, 36864
    s_mul_i32 s35, s35, 45056
    s_add_u32 s35, s35, s55
    buffer_load_dwordx4 v28, s[40:43], s35 offen offset:0 sc1 lds
    buffer_load_dwordx4 v28, s[40:43], s35 offen offset:1024 sc1 lds
    buffer_load_dwordx4 v28, s[40:43], s35 offen offset:2048 sc1 lds
    s_waitcnt vmcnt(10)
    v_mfma_f32_32x32x16_bf16 v[48:63], v[236:239], v[240:243], v[48:63]
    v_mfma_f32_32x32x16_bf16 v[64:79], v[232:235], v[244:247], v[64:79]
    v_mfma_f32_32x32x16_bf16 v[80:95], v[236:239], v[244:247], v[80:95]
    v_mfma_f32_32x32x16_bf16 v[32:47], v[232:235], v[240:243], v[32:47]
    s_setprio 2
    v_mov_b32 v4, 0x27f08
    s_mov_b32 s34, 400000
CH_W3:
    ds_read_b32 v12, v4 offset:0
    s_sub_u32 s34, s34, 1
    s_cmp_eq_u32 s34, 0
    s_cbranch_scc1 CH_X3
    s_waitcnt lgkmcnt(0)
    v_cmp_gt_u32 vcc, 9, v12
    s_cbranch_vccnz CH_W3
CH_X3:
    s_waitcnt lgkmcnt(0)
    s_mul_i32 s34, s29, 6
    s_add_u32 s34, s34, 1
    s_add_u32 s35, s34, s51
    s_and_b32 s35, s35, 31
    s_mul_i32 s34, s34, 3072
    s_add_u32 m0, s34, 36864
    s_mul_i32 s35, s35, 45056
    s_add_u32 s35, s35, s55
    buffer_load_dwordx4 v28, s[40:43], s35 offen offset:0 sc1 lds
    buffer_load_dwordx4 v28, s[40:43], s35 offen offset:1024 sc1 lds
    buffer_load_dwordx4 v28, s[40:43], s35 offen offset:2048 sc1 lds
    s_mul_i32 s34, s29, 6
    s_add_u32 s34, s34, 2
    s_add_u32 s35, s34, s51
    s_and_b32 s35, s35, 31
    s_mul_i32 s34, s34, 3072
    s_add_u32 m0, s34, 36864
    s_mul_i32 s35, s35, 45056
    s_add_u32 s35, s35, s55
    buffer_load_dwordx4 v28, s[40:43], s35 offen offset:0 sc1 lds
    buffer_load_dwordx4 v28, s[40:43], s35 offen offset:1024 sc1 lds
    buffer_load_dwordx4 v28, s[40:43], s35 offen offset:2048 sc1 lds
    s_mul_i32 s34, s29, 6
    s_add_u32 s34, s34, 3
    s_add_u32 s35, s34, s51
    s_and_b32 s35, s35, 31
    s_mul_i32 s34, s34, 3072
    s_add_u32 m0, s34, 36864
    s_mul_i32 s35, s35, 45056
    s_add_u32 s35, s35, s55
    buffer_load_dwordx4 v28, s[40:43], s35 offen offset:0 sc1 lds
    buffer_load_dwordx4 v28, s[40:43], s35 offen offset:1024 sc1 lds
    buffer_load_dwordx4 v28, s[40:43], s35 offen offset:2048 sc1 lds
    s_setprio 0
    ds_write_b128 v14, v[48:51] offset:0
    ds_write_b128 v14, v[52:55] offset:1024
    ds_write_b128 v14, v[56:59] offset:2048
    ds_write_b128 v14, v[60:63] offset:3072
    ds_write_b128 v14, v[64:67] offset:4096
    ds_write_b128 v14, v[68:71] offset:5120
    ds_write_b128 v14, v[72:75] offset:6144
    ds_write_b128 v14, v[76:79] offset:7168
    ds_write_b128 v14, v[80:83] offset:8192
    ds_write_b128 v14, v[84:87] offset:9216
    ds_write_b128 v14, v[88:91] offset:10240
    ds_write_b128 v14, v[92:95] offset:11264
    s_setprio 2
    v_add_u32 v11, 1, v11
    s_add_u32 s39, s39, 1
    s_waitcnt lgkmcnt(0)
    ds_write_b32 v9, v11 offset:34304
    s_waitcnt vmcnt(12)
    v_pk_add_f32 v[104:105], v[104:105], v[106:107]
    v_pk_add_f32 v[108:109], v[108:109], v[110:111]
    v_pk_add_f32 v[104:105], v[104:105], v[108:109]
    ds_write_b64 v6, v[104:105] offset:35392
    v_permlane32_swap_b32 v96, v98
    v_permlane32_swap_b32 v97, v99
    v_permlane32_swap_b32 v100, v102
    v_permlane32_swap_b32 v101, v103
    v_mul_f32 v252, v252, v253
    v_sub_f32 v254, 0, v252
    v_sub_f32 v255, 0, v252
    v_mov_b32 v252, v253
    v_lshlrev_b32 v120, 16, v96
    v_and_b32 v121, 0xffff0000, v96
    v_lshlrev_b32 v122, 16, v97
    v_and_b32 v123, 0xffff0000, v97
    v_lshlrev_b32 v124, 16, v98
    v_and_b32 v125, 0xffff0000, v98
    v_lshlrev_b32 v126, 16, v99
    v_and_b32 v127, 0xffff0000, v99
    v_lshlrev_b32 v128, 16, v100
    v_and_b32 v129, 0xffff0000, v100
    v_lshlrev_b32 v130, 16, v101
    v_and_b32 v131, 0xffff0000, v101
    v_lshlrev_b32 v132, 16, v102
    v_and_b32 v133, 0xffff0000, v102
    v_lshlrev_b32 v134, 16, v103
    v_and_b32 v135, 0xffff0000, v103
    v_pk_fma_f32 v[136:137], v[120:121], v[252:253], v[254:255]
    v_pk_fma_f32 v[138:139], v[122:123], v[252:253], v[254:255]
    v_pk_fma_f32 v[140:141], v[124:125], v[252:253], v[254:255]
    v_pk_fma_f32 v[142:143], v[126:127], v[252:253], v[254:255]
    v_pk_fma_f32 v[144:145], v[128:129], v[252:253], v[254:255]
    v_pk_fma_f32 v[146:147], v[130:131], v[252:253], v[254:255]
    v_pk_fma_f32 v[148:149], v[132:133], v[252:253], v[254:255]
    v_pk_fma_f32 v[150:151], v[134:135], v[252:253], v[254:255]
    v_pk_add_f32 v[32:33], v[32:33], v[136:137]
    v_pk_add_f32 v[34:35], v[34:35], v[138:139]
    v_pk_add_f32 v[36:37], v[36:37], v[140:141]
    v_pk_add_f32 v[38:39], v[38:39], v[142:143]
    v_pk_add_f32 v[40:41], v[40:41], v[144:145]
    v_pk_add_f32 v[42:43], v[42:43], v[146:147]
    v_pk_add_f32 v[44:45], v[44:45], v[148:149]
    v_pk_add_f32 v[46:47], v[46:47], v[150:151]
    s_mov_b32 s34, 400000
CH_W4:
    ds_read_b32 v12, v10 offset:34304
    s_sub_u32 s34, s34, 1
    s_cmp_eq_u32 s34, 0
    s_cbranch_scc1 CH_X4
    s_waitcnt lgkmcnt(0)
    v_cmp_gt_u32 vcc, s39, v12
    s_cbranch_vccnz CH_W4
CH_X4:
    s_waitcnt lgkmcnt(0)
    ds_read_b128 v[48:51], v18 offset:0
    ds_read_b128 v[52:55], v18 offset:1024
    ds_read_b128 v[56:59], v18 offset:2048
    ds_read_b128 v[60:63], v18 offset:3072
    ds_read_b128 v[64:67], v19 offset:0
    ds_read_b128 v[68:71], v19 offset:1024
    ds_read_b128 v[72:75], v19 offset:2048
    ds_read_b128 v[76:79], v19 offset:3072
    ds_read_b128 v[80:83], v20 offset:0
    ds_read_b128 v[84:87], v20 offset:1024
    ds_read_b128 v[88:91], v20 offset:2048
    ds_read_b128 v[92:95], v20 offset:3072
    s_waitcnt lgkmcnt(8)
    v_pk_add_f32 v[32:33], v[32:33], v[48:49]
    v_pk_add_f32 v[34:35], v[34:35], v[50:51]
    v_pk_add_f32 v[36:37], v[36:37], v[52:53]
    v_pk_add_f32 v[38:39], v[38:39], v[54:55]
    v_pk_add_f32 v[40:41], v[40:41], v[56:57]
    v_pk_add_f32 v[42:43], v[42:43], v[58:59]
    v_pk_add_f32 v[44:45], v[44:45], v[60:61]
    v_pk_add_f32 v[46:47], v[46:47], v[62:63]
    s_waitcnt lgkmcnt(4)
    v_pk_add_f32 v[32:33], v[32:33], v[64:65]
    v_pk_add_f32 v[34:35], v[34:35], v[66:67]
    v_pk_add_f32 v[36:37], v[36:37], v[68:69]
    v_pk_add_f32 v[38:39], v[38:39], v[70:71]
    v_pk_add_f32 v[40:41], v[40:41], v[72:73]
    v_pk_add_f32 v[42:43], v[42:43], v[74:75]
    v_pk_add_f32 v[44:45], v[44:45], v[76:77]
    v_pk_add_f32 v[46:47], v[46:47], v[78:79]
    s_waitcnt lgkmcnt(0)
    v_pk_add_f32 v[32:33], v[32:33], v[80:81]
    v_pk_add_f32 v[34:35], v[34:35], v[82:83]
    v_pk_add_f32 v[36:37], v[36:37], v[84:85]
    v_pk_add_f32 v[38:39], v[38:39], v[86:87]
    v_pk_add_f32 v[40:41], v[40:41], v[88:89]
    v_pk_add_f32 v[42:43], v[42:43], v[90:91]
    v_pk_add_f32 v[44:45], v[44:45], v[92:93]
    v_pk_add_f32 v[46:47], v[46:47], v[94:95]
    v_add_u32 v11, 1, v11
    s_add_u32 s39, s39, 1
    s_waitcnt lgkmcnt(0)
    ds_write_b32 v9, v11 offset:34304
    v_cvt_pk_bf16_f32 v136, v32, v33
    v_cvt_pk_bf16_f32 v137, v34, v35
    v_cvt_pk_bf16_f32 v138, v36, v37
    v_cvt_pk_bf16_f32 v139, v38, v39
    v_cvt_pk_bf16_f32 v140, v40, v41
    v_cvt_pk_bf16_f32 v141, v42, v43
    v_cvt_pk_bf16_f32 v142, v44, v45
    v_cvt_pk_bf16_f32 v143, v46, v47
    s_lshl_b32 s36, s33, 1
    s_add_u32 s36, s36, s48
    s_lshl_b32 s34, s36, 11
    s_lshl_b32 s35, s54, 15
    s_add_u32 s34, s34, s35
    s_add_u32 s34, s34, 0x800000
    s_lshl_b32 s35, s33, 2
    s_add_u32 s35, s35, s29
    s_lshl_b32 s35, s35, 10
    s_lshl_b32 s37, s32, 16
    s_add_u32 s35, s35, s37
    s_add_u32 s35, s35, 0xa00000
    s_add_u32 s37, s35, 0x8000
    v_mov_b32 v152, -1
    v_mov_b32 v153, -1
    v_mov_b32 v154, -1
    v_mov_b32 v155, -1
    buffer_store_dwordx4 v[152:155], v28, s[40:43], s35 offen sc1
    buffer_store_dwordx4 v[152:155], v28, s[40:43], s37 offen sc1
    buffer_store_dwordx4 v[136:139], v28, s[40:43], s34 offen sc1
    buffer_store_dwordx4 v[140:143], v28, s[40:43], s34 offen offset:1024 sc1
    v_pk_add_f32 v[248:249], v[32:33], v[34:35]
    v_pk_mul_f32 v[250:251], v[32:33], v[32:33]
    v_pk_fma_f32 v[250:251], v[34:35], v[34:35], v[250:251]
    v_pk_add_f32 v[248:249], v[248:249], v[36:37]
    v_pk_fma_f32 v[250:251], v[36:37], v[36:37], v[250:251]
    v_pk_add_f32 v[248:249], v[248:249], v[38:39]
    v_pk_fma_f32 v[250:251], v[38:39], v[38:39], v[250:251]
    v_pk_add_f32 v[248:249], v[248:249], v[40:41]
    v_pk_fma_f32 v[250:251], v[40:41], v[40:41], v[250:251]
    v_pk_add_f32 v[248:249], v[248:249], v[42:43]
    v_pk_fma_f32 v[250:251], v[42:43], v[42:43], v[250:251]
    v_pk_add_f32 v[248:249], v[248:249], v[44:45]
    v_pk_fma_f32 v[250:251], v[44:45], v[44:45], v[250:251]
    v_pk_add_f32 v[248:249], v[248:249], v[46:47]
    v_pk_fma_f32 v[250:251], v[46:47], v[46:47], v[250:251]
    v_add_f32 v248, v248, v249
    v_add_f32 v249, v250, v251
    v_mov_b32 v4, v248
    s_nop 1
    v_permlane32_swap_b32 v248, v4
    v_add_f32 v248, v248, v4
    v_mov_b32 v5, v249
    s_nop 1
    v_permlane32_swap_b32 v249, v5
    v_add_f32 v249, v249, v5
    s_lshl_b32 s34, s36, 14
    s_add_u32 s34, s34, 0x1610000
    buffer_store_dwordx2 v[248:249], v24, s[40:43], s34 offen sc1
    v_pk_add_f32 v[32:33], v[32:33], v[120:121]
    v_pk_add_f32 v[34:35], v[34:35], v[122:123]
    v_pk_add_f32 v[36:37], v[36:37], v[124:125]
    v_pk_add_f32 v[38:39], v[38:39], v[126:127]
    v_pk_add_f32 v[40:41], v[40:41], v[128:129]
    v_pk_add_f32 v[42:43], v[42:43], v[130:131]
    v_pk_add_f32 v[44:45], v[44:45], v[132:133]
    v_pk_add_f32 v[46:47], v[46:47], v[134:135]
    s_mov_b32 s34, 400000
CH_W5:
    ds_read_b32 v12, v10 offset:34304
    s_sub_u32 s34, s34, 1
    s_cmp_eq_u32 s34, 0
    s_cbranch_scc1 CH_X5
    s_waitcnt lgkmcnt(0)
    v_cmp_gt_u32 vcc, s39, v12
    s_cbranch_vccnz CH_W5
CH_X5:
    s_waitcnt lgkmcnt(0)
    s_waitcnt vmcnt(0)
    s_mov_b64 exec, 1
    v_mov_b32 v4, 1
    ds_add_rtn_u32 v5, v25, v4 offset:35328
    s_add_u32 s35, s38, 0
    s_waitcnt lgkmcnt(0)
    v_cmp_ne_u32 vcc, 3, v5
    s_cbranch_vccnz CH_S6
    s_mov_b64 exec, 15
    v_mov_b32 v4, 1
    v_lshlrev_b32 v5, 8, v1
    buffer_atomic_add v4, v5, s[40:43], s35 offen sc1
CH_S6:
    s_mov_b64 exec, -1
    s_setprio 0
    s_mul_i32 s34, s29, 6
    s_add_u32 s34, s34, 4
    s_add_u32 s35, s34, s51
    s_and_b32 s35, s35, 31
    s_mul_i32 s34, s34, 3072
    s_add_u32 m0, s34, 36864
    s_mul_i32 s35, s35, 45056
    s_add_u32 s35, s35, s55
    buffer_load_dwordx4 v28, s[40:43], s35 offen offset:0 sc1 lds
    buffer_load_dwordx4 v28, s[40:43], s35 offen offset:1024 sc1 lds
    buffer_load_dwordx4 v28, s[40:43], s35 offen offset:2048 sc1 lds
    s_mul_i32 s34, s29, 6
    s_add_u32 s34, s34, 5
    s_add_u32 s35, s34, s51
    s_and_b32 s35, s35, 31
    s_mul_i32 s34, s34, 3072
    s_add_u32 m0, s34, 36864
    s_mul_i32 s35, s35, 45056
    s_add_u32 s35, s35, s55
    buffer_load_dwordx4 v28, s[40:43], s35 offen offset:0 sc1 lds
    buffer_load_dwordx4 v28, s[40:43], s35 offen offset:1024 sc1 lds
    buffer_load_dwordx4 v28, s[40:43], s35 offen offset:2048 sc1 lds
    s_mul_i32 s34, s29, 2
    s_add_u32 s34, s34, 24
    s_add_u32 s35, s34, s51
    s_and_b32 s35, s35, 31
    s_mul_i32 s34, s34, 3072
    s_add_u32 m0, s34, 36864
    s_mul_i32 s35, s35, 45056
    s_add_u32 s35, s35, s55
    buffer_load_dwordx4 v28, s[40:43], s35 offen offset:0 sc1 lds
    buffer_load_dwordx4 v28, s[40:43], s35 offen offset:1024 sc1 lds
    buffer_load_dwordx4 v28, s[40:43], s35 offen offset:2048 sc1 lds
    s_mul_i32 s34, s29, 2
    s_add_u32 s34, s34, 25
    s_add_u32 s35, s34, s51
    s_and_b32 s35, s35, 31
    s_mul_i32 s34, s34, 3072
    s_add_u32 m0, s34, 36864
    s_mul_i32 s35, s35, 45056
    s_add_u32 s35, s35, s55
    buffer_load_dwordx4 v28, s[40:43], s35 offen offset:0 sc1 lds
    buffer_load_dwordx4 v28, s[40:43], s35 offen offset:1024 sc1 lds
    buffer_load_dwordx4 v28, s[40:43], s35 offen offset:2048 sc1 lds
    s_lshl_b32 s34, s30, 7
    s_lshl_b32 s35, s29, 5
    s_add_u32 s34, s34, s35
    v_add_u32 v7, s34, v2
    v_lshlrev_b32 v7, 3, v7
    v_lshl_add_u32 v7, v3, 17, v7
    s_lshl_b32 s53, s34, 10
    s_add_u32 s53, s53, 0x800000
    s_mov_b32 s35, s57
    s_cmp_lg_u32 s29, 0
    s_cbranch_scc1 CH_Q7
    s_mov_b32 s34, 400000
    v_mov_b32 v12, 0
    s_mov_b64 exec, 1
CH_P7:
    buffer_atomic_umax v12, v25, s[40:43], s35 offen sc0 sc1
    s_sub_u32 s34, s34, 1
    s_cmp_eq_u32 s34, 0
    s_cbranch_scc1 CH_Q7
    s_waitcnt vmcnt(0)
    v_cmp_gt_u32 vcc, 16, v12
    s_cbranch_vccz CH_Q7
    s_sleep 4
    s_branch CH_P7
CH_Q7:
    s_mov_b64 exec, -1
    s_waitcnt vmcnt(0)
    v_add_u32 v11, 1, v11
    s_add_u32 s39, s39, 1
    s_waitcnt lgkmcnt(0)
    ds_write_b32 v9, v11 offset:34304
    s_mov_b32 s34, 400000
CH_W8:
    ds_read_b32 v12, v10 offset:34304
    s_sub_u32 s34, s34, 1
    s_cmp_eq_u32 s34, 0
    s_cbranch_scc1 CH_X8
    s_waitcnt lgkmcnt(0)
    v_cmp_gt_u32 vcc, s39, v12
    s_cbranch_vccz CH_X8
    s_sleep 2
    s_branch CH_W8
CH_X8:
    s_waitcnt lgkmcnt(0)
    s_cmp_eq_u32 s31, 15
    s_cbranch_scc1 CH_NO2
    s_mov_b32 s35, 0x1610000
    buffer_load_dwordx2 v[104:105], v7, s[40:43], s35 offen sc1
    s_add_u32 s35, s35, 0x4000
    buffer_load_dwordx2 v[106:107], v7, s[40:43], s35 offen sc1
    s_add_u32 s35, s35, 0x4000
    buffer_load_dwordx2 v[108:109], v7, s[40:43], s35 offen sc1
    s_add_u32 s35, s35, 0x4000
    buffer_load_dwordx2 v[110:111], v7, s[40:43], s35 offen sc1
    s_add_u32 s35, s35, 0x4000
    buffer_load_dwordx2 v[112:113], v7, s[40:43], s35 offen sc1
    s_add_u32 s35, s35, 0x4000
    buffer_load_dwordx2 v[114:115], v7, s[40:43], s35 offen sc1
    s_add_u32 s35, s35, 0x4000
    buffer_load_dwordx2 v[116:117], v7, s[40:43], s35 offen sc1
    s_add_u32 s35, s35, 0x4000
    buffer_load_dwordx2 v[118:119], v7, s[40:43], s35 offen sc1
    s_add_u32 s35, s35, 0x4000
    s_and_b32 s51, s51, 31
    s_lshl_b32 s34, s51, 10
    s_add_u32 s34, s34, s53
    s_add_u32 s51, s51, 1
    buffer_load_dwordx4 v[120:123], v28, s[40:43], s34 offen sc1
    s_and_b32 s51, s51, 31
    s_lshl_b32 s34, s51, 10
    s_add_u32 s34, s34, s53
    s_add_u32 s51, s51, 1
    buffer_load_dwordx4 v[124:127], v28, s[40:43], s34 offen sc1
    s_and_b32 s51, s51, 31
    s_lshl_b32 s34, s51, 10
    s_add_u32 s34, s34, s53
    s_add_u32 s51, s51, 1
    buffer_load_dwordx4 v[128:131], v28, s[40:43], s34 offen sc1
    s_and_b32 s51, s51, 31
    s_lshl_b32 s34, s51, 10
    s_add_u32 s34, s34, s53
    s_add_u32 s51, s51, 1
    buffer_load_dwordx4 v[132:135], v28, s[40:43], s34 offen sc1
    s_and_b32 s51, s51, 31
    s_lshl_b32 s34, s51, 10
    s_add_u32 s34, s34, s53
    s_add_u32 s51, s51, 1
    buffer_load_dwordx4 v[136:139], v28, s[40:43], s34 offen sc1
    s_and_b32 s51, s51, 31
    s_lshl_b32 s34, s51, 10
    s_add_u32 s34, s34, s53
    s_add_u32 s51, s51, 1
    buffer_load_dwordx4 v[140:143], v28, s[40:43], s34 offen sc1
    s_and_b32 s51, s51, 31
    s_lshl_b32 s34, s51, 10
    s_add_u32 s34, s34, s53
    s_add_u32 s51, s51, 1
    buffer_load_dwordx4 v[144:147], v28, s[40:43], s34 offen sc1
    s_and_b32 s51, s51, 31
    s_lshl_b32 s34, s51, 10
    s_add_u32 s34, s34, s53
    s_add_u32 s51, s51, 1
    buffer_load_dwordx4 v[148:151], v28, s[40:43], s34 offen sc1
    s_setprio 2
    s_waitcnt vmcnt(8)
    v_pk_add_f32 v[104:105], v[104:105], v[106:107]
    v_pk_add_f32 v[104:105], v[104:105], v[108:109]
    v_pk_add_f32 v[104:105], v[104:105], v[110:111]
    v_pk_add_f32 v[104:105], v[104:105], v[112:113]
    v_pk_add_f32 v[104:105], v[104:105], v[114:115]
    v_pk_add_f32 v[104:105], v[104:105], v[116:117]
    v_pk_add_f32 v[104:105], v[104:105], v[118:119]
    v_mov_b32 v248, v104
    v_mov_b32 v250, v105
    ds_read_b128 v[96:99], v26 offset:0
    ds_read_b128 v[100:103], v26 offset:1024
    ds_read_b128 v[104:107], v26 offset:2048
    v_mov_b32 v4, v248
    s_nop 1
    v_permlane32_swap_b32 v248, v4
    v_add_f32 v248, v248, v4
    v_mov_b32 v5, v250
    s_nop 1
    v_permlane32_swap_b32 v250, v5
    v_add_f32 v250, v250, v5
    v_mul_f32 v248, 0xbb000000, v248
    v_mul_f32 v4, v248, v248
    v_mov_b32 v5, 0x3b000000
    v_fma_f32 v4, v250, v5, -v4
    v_max_f32 v4, 0, v4
    v_add_f32 v4, 0x3727c5ac, v4
    v_rsq_f32 v250, v4
    v_mov_b32 v249, v248
    v_rcp_f32 v30, v250
    v_mul_f32 v252, 0xc0135761, v250
    v_mul_f32 v254, v250, v250
    v_mul_f32 v254, v254, v250
    v_mul_f32 v254, 0xbdd2d3e8, v254
    v_mov_b32 v31, v30
    v_mov_b32 v253, v252
    v_mov_b32 v255, v254
    s_setprio 0
    ds_read_b128 v[108:111], v26 offset:3072
    ds_read_b128 v[112:115], v26 offset:4096
    ds_read_b128 v[116:119], v26 offset:5120
    s_and_b32 s51, s51, 31
    s_lshl_b32 s34, s51, 10
    s_add_u32 s34, s34, s53
    s_add_u32 s51, s51, 1
    buffer_load_dwordx4 v[152:155], v28, s[40:43], s34 offen sc1
    s_waitcnt vmcnt(8)
    s_waitcnt lgkmcnt(3)
    v_mfma_f32_32x32x16_bf16 v[48:63], v[96:99], v[120:123], 0
    v_mfma_f32_32x32x16_bf16 v[64:79], v[100:103], v[120:123], 0
    v_mfma_f32_32x32x16_bf16 v[80:95], v[104:107], v[120:123], 0
    ds_read_b128 v[96:99], v26 offset:6144
    ds_read_b128 v[100:103], v26 offset:7168
    ds_read_b128 v[104:107], v26 offset:8192
    s_and_b32 s51, s51, 31
    s_lshl_b32 s34, s51, 10
    s_add_u32 s34, s34, s53
    s_add_u32 s51, s51, 1
    buffer_load_dwordx4 v[156:159], v28, s[40:43], s34 offen sc1
    s_waitcnt vmcnt(8)
    s_waitcnt lgkmcnt(3)
    v_mfma_f32_32x32x16_bf16 v[48:63], v[108:111], v[124:127], v[48:63]
    v_mfma_f32_32x32x16_bf16 v[64:79], v[112:115], v[124:127], v[64:79]
    v_mfma_f32_32x32x16_bf16 v[80:95], v[116:119], v[124:127], v[80:95]
    ds_read_b128 v[108:111], v26 offset:9216
    ds_read_b128 v[112:115], v26 offset:10240
    ds_read_b128 v[116:119], v26 offset:11264
    s_and_b32 s51, s51, 31
    s_lshl_b32 s34, s51, 10
    s_add_u32 s34, s34, s53
    s_add_u32 s51, s51, 1
    buffer_load_dwordx4 v[160:163], v28, s[40:43], s34 offen sc1
    s_waitcnt vmcnt(8)
    s_waitcnt lgkmcnt(3)
    v_mfma_f32_32x32x16_bf16 v[48:63], v[96:99], v[128:131], v[48:63]
    v_mfma_f32_32x32x16_bf16 v[64:79], v[100:103], v[128:131], v[64:79]
    v_mfma_f32_32x32x16_bf16 v[80:95], v[104:107], v[128:131], v[80:95]
    ds_read_b128 v[96:99], v26 offset:12288
    ds_read_b128 v[100:103], v26 offset:13312
    ds_read_b128 v[104:107], v26 offset:14336
    s_and_b32 s51, s51, 31
    s_lshl_b32 s34, s51, 10
    s_add_u32 s34, s34, s53
    s_add_u32 s51, s51, 1
    buffer_load_dwordx4 v[164:167], v28, s[40:43], s34 offen sc1
    s_waitcnt vmcnt(8)
    s_waitcnt lgkmcnt(3)
    s_setprio 2
    v_mfma_f32_32x32x16_bf16 v[48:63], v[108:111], v[132:135], v[48:63]
    v_mfma_f32_32x32x16_bf16 v[64:79], v[112:115], v[132:135], v[64:79]
    v_mfma_f32_32x32x16_bf16 v[80:95], v[116:119], v[132:135], v[80:95]
    s_setprio 0
    ds_read_b128 v[108:111], v26 offset:15360
    ds_read_b128 v[112:115], v26 offset:16384
    ds_read_b128 v[116:119], v26 offset:17408
    s_and_b32 s51, s51, 31
    s_lshl_b32 s34, s51, 10
    s_add_u32 s34, s34, s53
    s_add_u32 s51, s51, 1
    buffer_load_dwordx4 v[168:171], v28, s[40:43], s34 offen sc1
    s_waitcnt vmcnt(8)
    s_waitcnt lgkmcnt(3)
    v_mfma_f32_32x32x16_bf16 v[48:63], v[96:99], v[136:139], v[48:63]
    v_mfma_f32_32x32x16_bf16 v[64:79], v[100:103], v[136:139], v[64:79]
    v_mfma_f32_32x32x16_bf16 v[80:95], v[104:107], v[136:139], v[80:95]
    ds_read_b128 v[96:99], v26 offset:18432
    ds_read_b128 v[100:103], v26 offset:19456
    ds_read_b128 v[104:107], v26 offset:20480
    s_and_b32 s51, s51, 31
    s_lshl_b32 s34, s51, 10
    s_add_u32 s34, s34, s53
    s_add_u32 s51, s51, 1
    buffer_load_dwordx4 v[172:175], v28, s[40:43], s34 offen sc1
    s_waitcnt vmcnt(8)
    s_waitcnt lgkmcnt(3)
    v_mfma_f32_32x32x16_bf16 v[48:63], v[108:111], v[140:143], v[48:63]
    v_mfma_f32_32x32x16_bf16 v[64:79], v[112:115], v[140:143], v[64:79]
    v_mfma_f32_32x32x16_bf16 v[80:95], v[116:119], v[140:143], v[80:95]
    ds_read_b128 v[108:111], v26 offset:21504
    ds_read_b128 v[112:115], v26 offset:22528
    ds_read_b128 v[116:119], v26 offset:23552
    s_and_b32 s51, s51, 31
    s_lshl_b32 s34, s51, 10
    s_add_u32 s34, s34, s53
    s_add_u32 s51, s51, 1
    buffer_load_dwordx4 v[176:179], v28, s[40:43], s34 offen sc1
    s_waitcnt vmcnt(8)
    s_waitcnt lgkmcnt(3)
    v_mfma_f32_32x32x16_bf16 v[48:63], v[96:99], v[144:147], v[48:63]
    v_mfma_f32_32x32x16_bf16 v[64:79], v[100:103], v[144:147], v[64:79]
    v_mfma_f32_32x32x16_bf16 v[80:95], v[104:107], v[144:147], v[80:95]
    ds_read_b128 v[96:99], v26 offset:24576
    ds_read_b128 v[100:103], v26 offset:25600
    ds_read_b128 v[104:107], v26 offset:26624
    s_and_b32 s51, s51, 31
    s_lshl_b32 s34, s51, 10
    s_add_u32 s34, s34, s53
    s_add_u32 s51, s51, 1
    buffer_load_dwordx4 v[180:183], v28, s[40:43], s34 offen sc1
    s_waitcnt vmcnt(8)
    s_waitcnt lgkmcnt(3)
    s_setprio 2
    v_mfma_f32_32x32x16_bf16 v[48:63], v[108:111], v[148:151], v[48:63]
    v_mfma_f32_32x32x16_bf16 v[64:79], v[112:115], v[148:151], v[64:79]
    v_mfma_f32_32x32x16_bf16 v[80:95], v[116:119], v[148:151], v[80:95]
    s_setprio 0
    ds_read_b128 v[108:111], v26 offset:27648
    ds_read_b128 v[112:115], v26 offset:28672
    ds_read_b128 v[116:119], v26 offset:29696
    s_and_b32 s51, s51, 31
    s_lshl_b32 s34, s51, 10
    s_add_u32 s34, s34, s53
    s_add_u32 s51, s51, 1
    buffer_load_dwordx4 v[184:187], v28, s[40:43], s34 offen sc1
    s_waitcnt vmcnt(8)
    s_waitcnt lgkmcnt(3)
    v_mfma_f32_32x32x16_bf16 v[48:63], v[96:99], v[152:155], v[48:63]
    v_mfma_f32_32x32x16_bf16 v[64:79], v[100:103], v[152:155], v[64:79]
    v_mfma_f32_32x32x16_bf16 v[80:95], v[104:107], v[152:155], v[80:95]
    ds_read_b128 v[96:99], v26 offset:30720
    ds_read_b128 v[100:103], v26 offset:31744
    ds_read_b128 v[104:107], v26 offset:32768
    s_and_b32 s51, s51, 31
    s_lshl_b32 s34, s51, 10
    s_add_u32 s34, s34, s53
    s_add_u32 s51, s51, 1
    buffer_load_dwordx4 v[188:191], v28, s[40:43], s34 offen sc1
    s_waitcnt vmcnt(8)
    s_waitcnt lgkmcnt(3)
    v_mfma_f32_32x32x16_bf16 v[48:63], v[108:111], v[156:159], v[48:63]
    v_mfma_f32_32x32x16_bf16 v[64:79], v[112:115], v[156:159], v[64:79]
    v_mfma_f32_32x32x16_bf16 v[80:95], v[116:119], v[156:159], v[80:95]
    ds_read_b128 v[108:111], v26 offset:33792
    ds_read_b128 v[112:115], v26 offset:34816
    ds_read_b128 v[116:119], v26 offset:35840
    s_and_b32 s51, s51, 31
    s_lshl_b32 s34, s51, 10
    s_add_u32 s34, s34, s53
    s_add_u32 s51, s51, 1
    buffer_load_dwordx4 v[192:195], v28, s[40:43], s34 offen sc1
    s_waitcnt vmcnt(8)
    s_waitcnt lgkmcnt(3)
    v_mfma_f32_32x32x16_bf16 v[48:63], v[96:99], v[160:163], v[48:63]
    v_mfma_f32_32x32x16_bf16 v[64:79], v[100:103], v[160:163], v[64:79]
    v_mfma_f32_32x32x16_bf16 v[80:95], v[104:107], v[160:163], v[80:95]
    ds_read_b128 v[96:99], v26 offset:36864
    ds_read_b128 v[100:103], v26 offset:37888
    ds_read_b128 v[104:107], v26 offset:38912
    s_and_b32 s51, s51, 31
    s_lshl_b32 s34, s51, 10
    s_add_u32 s34, s34, s53
    s_add_u32 s51, s51, 1
    buffer_load_dwordx4 v[196:199], v28, s[40:43], s34 offen sc1
    s_waitcnt vmcnt(8)
    s_waitcnt lgkmcnt(3)
    s_setprio 2
    v_mfma_f32_32x32x16_bf16 v[48:63], v[108:111], v[164:167], v[48:63]
    v_mfma_f32_32x32x16_bf16 v[64:79], v[112:115], v[164:167], v[64:79]
    v_mfma_f32_32x32x16_bf16 v[80:95], v[116:119], v[164:167], v[80:95]
    s_setprio 0
    ds_read_b128 v[108:111], v26 offset:39936
    ds_read_b128 v[112:115], v26 offset:40960
    ds_read_b128 v[116:119], v26 offset:41984
    s_and_b32 s51, s51, 31
    s_lshl_b32 s34, s51, 10
    s_add_u32 s34, s34, s53
    s_add_u32 s51, s51, 1
    buffer_load_dwordx4 v[200:203], v28, s[40:43], s34 offen sc1
    s_waitcnt vmcnt(8)
    s_waitcnt lgkmcnt(3)
    v_mfma_f32_32x32x16_bf16 v[48:63], v[96:99], v[168:171], v[48:63]
    v_mfma_f32_32x32x16_bf16 v[64:79], v[100:103], v[168:171], v[64:79]
    v_mfma_f32_32x32x16_bf16 v[80:95], v[104:107], v[168:171], v[80:95]
    ds_read_b128 v[96:99], v26 offset:43008
    ds_read_b128 v[100:103], v26 offset:44032
    ds_read_b128 v[104:107], v26 offset:45056
    s_and_b32 s51, s51, 31
    s_lshl_b32 s34, s51, 10
    s_add_u32 s34, s34, s53
    s_add_u32 s51, s51, 1
    buffer_load_dwordx4 v[204:207], v28, s[40:43], s34 offen sc1
    s_waitcnt vmcnt(8)
    s_waitcnt lgkmcnt(3)
    v_mfma_f32_32x32x16_bf16 v[48:63], v[108:111], v[172:175], v[48:63]
    v_mfma_f32_32x32x16_bf16 v[64:79], v[112:115], v[172:175], v[64:79]
    v_mfma_f32_32x32x16_bf16 v[80:95], v[116:119], v[172:175], v[80:95]
    ds_read_b128 v[108:111], v26 offset:46080
    ds_read_b128 v[112:115], v26 offset:47104
    ds_read_b128 v[116:119], v26 offset:48128
    s_and_b32 s51, s51, 31
    s_lshl_b32 s34, s51, 10
    s_add_u32 s34, s34, s53
    s_add_u32 s51, s51, 1
    buffer_load_dwordx4 v[208:211], v28, s[40:43], s34 offen sc1
    s_waitcnt vmcnt(8)
    s_waitcnt lgkmcnt(3)
    v_mfma_f32_32x32x16_bf16 v[48:63], v[96:99], v[176:179], v[48:63]
    v_mfma_f32_32x32x16_bf16 v[64:79], v[100:103], v[176:179], v[64:79]
    v_mfma_f32_32x32x16_bf16 v[80:95], v[104:107], v[176:179], v[80:95]
    ds_read_b128 v[96:99], v27 offset:0
    ds_read_b128 v[100:103], v27 offset:1024
    ds_read_b128 v[104:107], v27 offset:2048
    s_and_b32 s51, s51, 31
    s_lshl_b32 s34, s51, 10
    s_add_u32 s34, s34, s53
    s_add_u32 s51, s51, 1
    buffer_load_dwordx4 v[212:215], v28, s[40:43], s34 offen sc1
    s_waitcnt vmcnt(8)
    s_waitcnt lgkmcnt(3)
    s_setprio 2
    v_mfma_f32_32x32x16_bf16 v[48:63], v[108:111], v[180:183], v[48:63]
    v_mfma_f32_32x32x16_bf16 v[64:79], v[112:115], v[180:183], v[64:79]
    v_mfma_f32_32x32x16_bf16 v[80:95], v[116:119], v[180:183], v[80:95]
    s_setprio 0
    ds_read_b128 v[108:111], v27 offset:3072
    ds_read_b128 v[112:115], v27 offset:4096
    ds_read_b128 v[116:119], v27 offset:5120
    s_and_b32 s51, s51, 31
    s_lshl_b32 s34, s51, 10
    s_add_u32 s34, s34, s53
    s_add_u32 s51, s51, 1
    buffer_load_dwordx4 v[216:219], v28, s[40:43], s34 offen sc1
    s_waitcnt vmcnt(8)
    s_waitcnt lgkmcnt(3)
    v_mfma_f32_32x32x16_bf16 v[48:63], v[96:99], v[184:187], v[48:63]
    v_mfma_f32_32x32x16_bf16 v[64:79], v[100:103], v[184:187], v[64:79]
    v_mfma_f32_32x32x16_bf16 v[80:95], v[104:107], v[184:187], v[80:95]
    ds_read_b128 v[96:99], v27 offset:6144
    ds_read_b128 v[100:103], v27 offset:7168
    ds_read_b128 v[104:107], v27 offset:8192
    s_and_b32 s51, s51, 31
    s_lshl_b32 s34, s51, 10
    s_add_u32 s34, s34, s53
    s_add_u32 s51, s51, 1
    buffer_load_dwordx4 v[220:223], v28, s[40:43], s34 offen sc1
    s_waitcnt vmcnt(8)
    s_waitcnt lgkmcnt(3)
    v_mfma_f32_32x32x16_bf16 v[48:63], v[108:111], v[188:191], v[48:63]
    v_mfma_f32_32x32x16_bf16 v[64:79], v[112:115], v[188:191], v[64:79]
    v_mfma_f32_32x32x16_bf16 v[80:95], v[116:119], v[188:191], v[80:95]
    ds_read_b128 v[108:111], v27 offset:9216
    ds_read_b128 v[112:115], v27 offset:10240
    ds_read_b128 v[116:119], v27 offset:11264
    s_and_b32 s51, s51, 31
    s_lshl_b32 s34, s51, 10
    s_add_u32 s34, s34, s53
    s_add_u32 s51, s51, 1
    buffer_load_dwordx4 v[224:227], v28, s[40:43], s34 offen sc1
    s_waitcnt vmcnt(8)
    s_waitcnt lgkmcnt(3)
    v_mfma_f32_32x32x16_bf16 v[48:63], v[96:99], v[192:195], v[48:63]
    v_mfma_f32_32x32x16_bf16 v[64:79], v[100:103], v[192:195], v[64:79]
    v_mfma_f32_32x32x16_bf16 v[80:95], v[104:107], v[192:195], v[80:95]
    ds_read_b128 v[96:99], v27 offset:12288
    ds_read_b128 v[100:103], v27 offset:13312
    ds_read_b128 v[104:107], v27 offset:14336
    s_and_b32 s51, s51, 31
    s_lshl_b32 s34, s51, 10
    s_add_u32 s34, s34, s53
    s_add_u32 s51, s51, 1
    buffer_load_dwordx4 v[228:231], v28, s[40:43], s34 offen sc1
    s_waitcnt vmcnt(8)
    s_waitcnt lgkmcnt(3)
    s_setprio 2
    v_mfma_f32_32x32x16_bf16 v[48:63], v[108:111], v[196:199], v[48:63]
    v_mfma_f32_32x32x16_bf16 v[64:79], v[112:115], v[196:199], v[64:79]
    v_mfma_f32_32x32x16_bf16 v[80:95], v[116:119], v[196:199], v[80:95]
    s_setprio 0
    ds_read_b128 v[108:111], v27 offset:15360
    ds_read_b128 v[112:115], v27 offset:16384
    ds_read_b128 v[116:119], v27 offset:17408
    s_and_b32 s51, s51, 31
    s_lshl_b32 s34, s51, 10
    s_add_u32 s34, s34, s53
    s_add_u32 s51, s51, 1
    buffer_load_dwordx4 v[232:235], v28, s[40:43], s34 offen sc1
    s_waitcnt vmcnt(8)
    s_waitcnt lgkmcnt(3)
    v_mfma_f32_32x32x16_bf16 v[48:63], v[96:99], v[200:203], v[48:63]
    v_mfma_f32_32x32x16_bf16 v[64:79], v[100:103], v[200:203], v[64:79]
    v_mfma_f32_32x32x16_bf16 v[80:95], v[104:107], v[200:203], v[80:95]
    ds_read_b128 v[96:99], v27 offset:18432
    ds_read_b128 v[100:103], v27 offset:19456
    ds_read_b128 v[104:107], v27 offset:20480
    s_and_b32 s51, s51, 31
    s_lshl_b32 s34, s51, 10
    s_add_u32 s34, s34, s53
    s_add_u32 s51, s51, 1
    buffer_load_dwordx4 v[236:239], v28, s[40:43], s34 offen sc1
    s_waitcnt vmcnt(8)
    s_waitcnt lgkmcnt(3)
    v_mfma_f32_32x32x16_bf16 v[48:63], v[108:111], v[204:207], v[48:63]
    v_mfma_f32_32x32x16_bf16 v[64:79], v[112:115], v[204:207], v[64:79]
    v_mfma_f32_32x32x16_bf16 v[80:95], v[116:119], v[204:207], v[80:95]
    ds_read_b128 v[108:111], v27 offset:21504
    ds_read_b128 v[112:115], v27 offset:22528
    ds_read_b128 v[116:119], v27 offset:23552
    s_and_b32 s51, s51, 31
    s_lshl_b32 s34, s51, 10
    s_add_u32 s34, s34, s53
    s_add_u32 s51, s51, 1
    buffer_load_dwordx4 v[240:243], v28, s[40:43], s34 offen sc1
    s_waitcnt vmcnt(8)
    s_waitcnt lgkmcnt(3)
    v_mfma_f32_32x32x16_bf16 v[48:63], v[96:99], v[208:211], v[48:63]
    v_mfma_f32_32x32x16_bf16 v[64:79], v[100:103], v[208:211], v[64:79]
    v_mfma_f32_32x32x16_bf16 v[80:95], v[104:107], v[208:211], v[80:95]
    ds_read_b128 v[96:99], v27 offset:24576
    ds_read_b128 v[100:103], v27 offset:25600
    ds_read_b128 v[104:107], v27 offset:26624
    s_and_b32 s51, s51, 31
    s_lshl_b32 s34, s51, 10
    s_add_u32 s34, s34, s53
    s_add_u32 s51, s51, 1
    buffer_load_dwordx4 v[244:247], v28, s[40:43], s34 offen sc1
    s_waitcnt vmcnt(8)
    s_waitcnt lgkmcnt(3)
    s_setprio 2
    v_mfma_f32_32x32x16_bf16 v[48:63], v[108:111], v[212:215], v[48:63]
    v_mfma_f32_32x32x16_bf16 v[64:79], v[112:115], v[212:215], v[64:79]
    v_mfma_f32_32x32x16_bf16 v[80:95], v[116:119], v[212:215], v[80:95]
    s_setprio 0
    ds_read_b128 v[108:111], v27 offset:27648
    ds_read_b128 v[112:115], v27 offset:28672
    ds_read_b128 v[116:119], v27 offset:29696
    s_waitcnt vmcnt(7)
    s_waitcnt lgkmcnt(3)
    v_mfma_f32_32x32x16_bf16 v[48:63], v[96:99], v[216:219], v[48:63]
    v_mfma_f32_32x32x16_bf16 v[64:79], v[100:103], v[216:219], v[64:79]
    v_mfma_f32_32x32x16_bf16 v[80:95], v[104:107], v[216:219], v[80:95]
    ds_read_b128 v[96:99], v27 offset:30720
    ds_read_b128 v[100:103], v27 offset:31744
    ds_read_b128 v[104:107], v27 offset:32768
    s_waitcnt vmcnt(6)
    s_waitcnt lgkmcnt(3)
    v_mfma_f32_32x32x16_bf16 v[48:63], v[108:111], v[220:223], v[48:63]
    v_mfma_f32_32x32x16_bf16 v[64:79], v[112:115], v[220:223], v[64:79]
    v_mfma_f32_32x32x16_bf16 v[80:95], v[116:119], v[220:223], v[80:95]
    ds_read_b128 v[108:111], v27 offset:33792
    ds_read_b128 v[112:115], v27 offset:34816
    ds_read_b128 v[116:119], v27 offset:35840
    s_waitcnt vmcnt(5)
    s_waitcnt lgkmcnt(3)
    v_mfma_f32_32x32x16_bf16 v[48:63], v[96:99], v[224:227], v[48:63]
    v_mfma_f32_32x32x16_bf16 v[64:79], v[100:103], v[224:227], v[64:79]
    v_mfma_f32_32x32x16_bf16 v[80:95], v[104:107], v[224:227], v[80:95]
    ds_read_b128 v[96:99], v27 offset:36864
    ds_read_b128 v[100:103], v27 offset:37888
    ds_read_b128 v[104:107], v27 offset:38912
    s_waitcnt vmcnt(4)
    s_waitcnt lgkmcnt(3)
    s_setprio 2
    v_mfma_f32_32x32x16_bf16 v[48:63], v[108:111], v[228:231], v[48:63]
    v_mfma_f32_32x32x16_bf16 v[64:79], v[112:115], v[228:231], v[64:79]
    v_mfma_f32_32x32x16_bf16 v[80:95], v[116:119], v[228:231], v[80:95]
    s_setprio 0
    ds_read_b128 v[108:111], v27 offset:39936
    ds_read_b128 v[112:115], v27 offset:40960
    ds_read_b128 v[116:119], v27 offset:41984
    s_waitcnt vmcnt(3)
    s_waitcnt lgkmcnt(3)
    v_mfma_f32_32x32x16_bf16 v[48:63], v[96:99], v[232:235], v[48:63]
    v_mfma_f32_32x32x16_bf16 v[64:79], v[100:103], v[232:235], v[64:79]
    v_mfma_f32_32x32x16_bf16 v[80:95], v[104:107], v[232:235], v[80:95]
    ds_read_b128 v[96:99], v27 offset:43008
    ds_read_b128 v[100:103], v27 offset:44032
    ds_read_b128 v[104:107], v27 offset:45056
    s_waitcnt vmcnt(2)
    s_waitcnt lgkmcnt(3)
    v_mfma_f32_32x32x16_bf16 v[48:63], v[108:111], v[236:239], v[48:63]
    v_mfma_f32_32x32x16_bf16 v[64:79], v[112:115], v[236:239], v[64:79]
    v_mfma_f32_32x32x16_bf16 v[80:95], v[116:119], v[236:239], v[80:95]
    ds_read_b128 v[108:111], v27 offset:46080
    ds_read_b128 v[112:115], v27 offset:47104
    ds_read_b128 v[116:119], v27 offset:48128
    s_waitcnt vmcnt(1)
    s_waitcnt lgkmcnt(3)
    v_mfma_f32_32x32x16_bf16 v[48:63], v[96:99], v[240:243], v[48:63]
    v_mfma_f32_32x32x16_bf16 v[64:79], v[100:103], v[240:243], v[64:79]
    v_mfma_f32_32x32x16_bf16 v[80:95], v[104:107], v[240:243], v[80:95]
    s_waitcnt vmcnt(0)
    s_waitcnt lgkmcnt(0)
    s_setprio 2
    v_mfma_f32_32x32x16_bf16 v[48:63], v[108:111], v[244:247], v[48:63]
    v_mfma_f32_32x32x16_bf16 v[64:79], v[112:115], v[244:247], v[64:79]
    v_mfma_f32_32x32x16_bf16 v[80:95], v[116:119], v[244:247], v[80:95]
    s_setprio 0
CH_NO2:
    s_setprio 2
    s_and_b32 s34, s32, 3
    s_mul_i32 s34, s34, 5
    s_mul_i32 s50, s33, 3
    s_add_u32 s50, s50, s34
    s_sub_u32 s34, s50, 22
    s_cmp_ge_u32 s50, 22
    s_cselect_b32 s50, s34, s50
    s_mov_b32 s51, s50
    s_mul_i32 s53, s29, 22
    v_lshlrev_b32 v4, 4, v3
    s_lshl_b32 s34, s30, 2
    s_add_u32 s34, s34, s29
    s_mul_i32 s36, s34, 98304
    s_mul_i32 s34, s31, 6144
    s_add_u32 s36, s36, s34
    s_add_u32 s36, s36, 0xc00000
    s_add_u32 s55, s36, 4096
    s_cmp_lg_u32 s31, 15
    s_cbranch_scc1 CH_DO2
    s_add_u32 s34, s50, s53
    s_add_u32 s50, s50, 1
    s_cmp_eq_u32 s50, 22
    s_cselect_b32 s50, 0, s50
    s_lshl_b32 s37, s34, 14
    s_add_u32 s37, s37, 0x1980000
    buffer_load_dwordx4 v[96:99], v16, s[40:43], s37 offen sc1
    buffer_load_dwordx4 v[100:103], v17, s[40:43], s37 offen sc1
    s_add_u32 s34, s50, s53
    s_add_u32 s50, s50, 1
    s_cmp_eq_u32 s50, 22
    s_cselect_b32 s50, 0, s50
    s_lshl_b32 s37, s34, 14
    s_add_u32 s37, s37, 0x1980000
    buffer_load_dwordx4 v[104:107], v16, s[40:43], s37 offen sc1
    buffer_load_dwordx4 v[108:111], v17, s[40:43], s37 offen sc1
    s_branch CH_NO2B
CH_DO2:
    ds_read_b128 v[176:179], v4 offset:35392
    ds_read_b128 v[180:183], v4 offset:35424
    ds_read_b128 v[184:187], v4 offset:35456
    ds_read_b128 v[188:191], v4 offset:35488
    s_waitcnt lgkmcnt(2)
    v_pk_fma_f32 v[48:49], v[176:177], v[248:249], v[48:49]
    v_pk_fma_f32 v[50:51], v[178:179], v[248:249], v[50:51]
    v_pk_fma_f32 v[52:53], v[180:181], v[248:249], v[52:53]
    v_pk_fma_f32 v[54:55], v[182:183], v[248:249], v[54:55]
    v_pk_mul_f32 v[240:241], v[48:49], v[48:49]
    v_pk_mul_f32 v[242:243], v[50:51], v[50:51]
    v_pk_mul_f32 v[244:245], v[52:53], v[52:53]
    v_pk_mul_f32 v[246:247], v[54:55], v[54:55]
    v_pk_fma_f32 v[240:241], v[240:241], v[254:255], v[252:253]
    v_pk_fma_f32 v[242:243], v[242:243], v[254:255], v[252:253]
    v_pk_fma_f32 v[244:245], v[244:245], v[254:255], v[252:253]
    v_pk_fma_f32 v[246:247], v[246:247], v[254:255], v[252:253]
    v_pk_mul_f32 v[240:241], v[240:241], v[48:49]
    v_pk_mul_f32 v[242:243], v[242:243], v[50:51]
    v_pk_mul_f32 v[244:245], v[244:245], v[52:53]
    v_pk_mul_f32 v[246:247], v[246:247], v[54:55]
    v_exp_f32 v240, v240
    v_exp_f32 v241, v241
    v_exp_f32 v242, v242
    v_exp_f32 v243, v243
    v_exp_f32 v244, v244
    v_exp_f32 v245, v245
    v_exp_f32 v246, v246
    v_exp_f32 v247, v247
    v_pk_fma_f32 v[240:241], v[240:241], v[30:31], v[30:31]
    v_pk_fma_f32 v[242:243], v[242:243], v[30:31], v[30:31]
    v_pk_fma_f32 v[244:245], v[244:245], v[30:31], v[30:31]
    v_pk_fma_f32 v[246:247], v[246:247], v[30:31], v[30:31]
    v_rcp_f32 v240, v240
    v_rcp_f32 v241, v241
    v_rcp_f32 v242, v242
    v_rcp_f32 v243, v243
    v_rcp_f32 v244, v244
    v_rcp_f32 v245, v245
    v_rcp_f32 v246, v246
    v_rcp_f32 v247, v247
    v_pk_mul_f32 v[48:49], v[48:49], v[240:241]
    v_pk_mul_f32 v[50:51], v[50:51], v[242:243]
    v_pk_mul_f32 v[52:53], v[52:53], v[244:245]
    v_pk_mul_f32 v[54:55], v[54:55], v[246:247]
    v_cvt_pk_bf16_f32 v216, v48, v49
    v_cvt_pk_bf16_f32 v217, v50, v51
    v_cvt_pk_bf16_f32 v218, v52, v53
    v_cvt_pk_bf16_f32 v219, v54, v55
    buffer_store_dwordx4 v[216:219], v28, s[40:43], s36 offen offset:0 sc1
    ds_read_b128 v[176:179], v4 offset:35520
    ds_read_b128 v[180:183], v4 offset:35552
    s_waitcnt lgkmcnt(2)
    v_pk_fma_f32 v[56:57], v[184:185], v[248:249], v[56:57]
    v_pk_fma_f32 v[58:59], v[186:187], v[248:249], v[58:59]
    v_pk_fma_f32 v[60:61], v[188:189], v[248:249], v[60:61]
    v_pk_fma_f32 v[62:63], v[190:191], v[248:249], v[62:63]
    v_pk_mul_f32 v[240:241], v[56:57], v[56:57]
    v_pk_mul_f32 v[242:243], v[58:59], v[58:59]
    v_pk_mul_f32 v[244:245], v[60:61], v[60:61]
    v_pk_mul_f32 v[246:247], v[62:63], v[62:63]
    v_pk_fma_f32 v[240:241], v[240:241], v[254:255], v[252:253]
    v_pk_fma_f32 v[242:243], v[242:243], v[254:255], v[252:253]
    v_pk_fma_f32 v[244:245], v[244:245], v[254:255], v[252:253]
    v_pk_fma_f32 v[246:247], v[246:247], v[254:255], v[252:253]
    v_pk_mul_f32 v[240:241], v[240:241], v[56:57]
    v_pk_mul_f32 v[242:243], v[242:243], v[58:59]
    v_pk_mul_f32 v[244:245], v[244:245], v[60:61]
    v_pk_mul_f32 v[246:247], v[246:247], v[62:63]
    v_exp_f32 v240, v240
    v_exp_f32 v241, v241
    v_exp_f32 v242, v242
    v_exp_f32 v243, v243
    v_exp_f32 v244, v244
    v_exp_f32 v245, v245
    v_exp_f32 v246, v246
    v_exp_f32 v247, v247
    v_pk_fma_f32 v[240:241], v[240:241], v[30:31], v[30:31]
    v_pk_fma_f32 v[242:243], v[242:243], v[30:31], v[30:31]
    v_pk_fma_f32 v[244:245], v[244:245], v[30:31], v[30:31]
    v_pk_fma_f32 v[246:247], v[246:247], v[30:31], v[30:31]
    v_rcp_f32 v240, v240
    v_rcp_f32 v241, v241
    v_rcp_f32 v242, v242
    v_rcp_f32 v243, v243
    v_rcp_f32 v244, v244
    v_rcp_f32 v245, v245
    v_rcp_f32 v246, v246
    v_rcp_f32 v247, v247
    v_pk_mul_f32 v[56:57], v[56:57], v[240:241]
    v_pk_mul_f32 v[58:59], v[58:59], v[242:243]
    v_pk_mul_f32 v[60:61], v[60:61], v[244:245]
    v_pk_mul_f32 v[62:63], v[62:63], v[246:247]
    v_cvt_pk_bf16_f32 v220, v56, v57
    v_cvt_pk_bf16_f32 v221, v58, v59
    v_cvt_pk_bf16_f32 v222, v60, v61
    v_cvt_pk_bf16_f32 v223, v62, v63
    buffer_store_dwordx4 v[220:223], v28, s[40:43], s36 offen offset:1024 sc1
    ds_read_b128 v[184:187], v4 offset:35584
    ds_read_b128 v[188:191], v4 offset:35616
    s_waitcnt lgkmcnt(2)
    v_pk_fma_f32 v[64:65], v[176:177], v[248:249], v[64:65]
    v_pk_fma_f32 v[66:67], v[178:179], v[248:249], v[66:67]
    v_pk_fma_f32 v[68:69], v[180:181], v[248:249], v[68:69]
    v_pk_fma_f32 v[70:71], v[182:183], v[248:249], v[70:71]
    v_pk_mul_f32 v[240:241], v[64:65], v[64:65]
    v_pk_mul_f32 v[242:243], v[66:67], v[66:67]
    v_pk_mul_f32 v[244:245], v[68:69], v[68:69]
    v_pk_mul_f32 v[246:247], v[70:71], v[70:71]
    v_pk_fma_f32 v[240:241], v[240:241], v[254:255], v[252:253]
    v_pk_fma_f32 v[242:243], v[242:243], v[254:255], v[252:253]
    v_pk_fma_f32 v[244:245], v[244:245], v[254:255], v[252:253]
    v_pk_fma_f32 v[246:247], v[246:247], v[254:255], v[252:253]
    v_pk_mul_f32 v[240:241], v[240:241], v[64:65]
    v_pk_mul_f32 v[242:243], v[242:243], v[66:67]
    v_pk_mul_f32 v[244:245], v[244:245], v[68:69]
    v_pk_mul_f32 v[246:247], v[246:247], v[70:71]
    v_exp_f32 v240, v240
    v_exp_f32 v241, v241
    v_exp_f32 v242, v242
    v_exp_f32 v243, v243
    v_exp_f32 v244, v244
    v_exp_f32 v245, v245
    v_exp_f32 v246, v246
    v_exp_f32 v247, v247
    v_pk_fma_f32 v[240:241], v[240:241], v[30:31], v[30:31]
    v_pk_fma_f32 v[242:243], v[242:243], v[30:31], v[30:31]
    v_pk_fma_f32 v[244:245], v[244:245], v[30:31], v[30:31]
    v_pk_fma_f32 v[246:247], v[246:247], v[30:31], v[30:31]
    v_rcp_f32 v240, v240
    v_rcp_f32 v241, v241
    v_rcp_f32 v242, v242
    v_rcp_f32 v243, v243
    v_rcp_f32 v244, v244
    v_rcp_f32 v245, v245
    v_rcp_f32 v246, v246
    v_rcp_f32 v247, v247
    v_pk_mul_f32 v[64:65], v[64:65], v[240:241]
    v_pk_mul_f32 v[66:67], v[66:67], v[242:243]
    v_pk_mul_f32 v[68:69], v[68:69], v[244:245]
    v_pk_mul_f32 v[70:71], v[70:71], v[246:247]
    v_cvt_pk_bf16_f32 v224, v64, v65
    v_cvt_pk_bf16_f32 v225, v66, v67
    v_cvt_pk_bf16_f32 v226, v68, v69
    v_cvt_pk_bf16_f32 v227, v70, v71
    buffer_store_dwordx4 v[224:227], v28, s[40:43], s36 offen offset:2048 sc1
    s_add_u32 s34, s50, s53
    s_add_u32 s50, s50, 1
    s_cmp_eq_u32 s50, 22
    s_cselect_b32 s50, 0, s50
    s_lshl_b32 s37, s34, 14
    s_add_u32 s37, s37, 0x1980000
    buffer_load_dwordx4 v[96:99], v16, s[40:43], s37 offen sc1
    buffer_load_dwordx4 v[100:103], v17, s[40:43], s37 offen sc1
    ds_read_b128 v[176:179], v4 offset:35648
    ds_read_b128 v[180:183], v4 offset:35680
    s_waitcnt lgkmcnt(2)
    v_pk_fma_f32 v[72:73], v[184:185], v[248:249], v[72:73]
    v_pk_fma_f32 v[74:75], v[186:187], v[248:249], v[74:75]
    v_pk_fma_f32 v[76:77], v[188:189], v[248:249], v[76:77]
    v_pk_fma_f32 v[78:79], v[190:191], v[248:249], v[78:79]
    v_pk_mul_f32 v[240:241], v[72:73], v[72:73]
    v_pk_mul_f32 v[242:243], v[74:75], v[74:75]
    v_pk_mul_f32 v[244:245], v[76:77], v[76:77]
    v_pk_mul_f32 v[246:247], v[78:79], v[78:79]
    v_pk_fma_f32 v[240:241], v[240:241], v[254:255], v[252:253]
    v_pk_fma_f32 v[242:243], v[242:243], v[254:255], v[252:253]
    v_pk_fma_f32 v[244:245], v[244:245], v[254:255], v[252:253]
    v_pk_fma_f32 v[246:247], v[246:247], v[254:255], v[252:253]
    v_pk_mul_f32 v[240:241], v[240:241], v[72:73]
    v_pk_mul_f32 v[242:243], v[242:243], v[74:75]
    v_pk_mul_f32 v[244:245], v[244:245], v[76:77]
    v_pk_mul_f32 v[246:247], v[246:247], v[78:79]
    v_exp_f32 v240, v240
    v_exp_f32 v241, v241
    v_exp_f32 v242, v242
    v_exp_f32 v243, v243
    v_exp_f32 v244, v244
    v_exp_f32 v245, v245
    v_exp_f32 v246, v246
    v_exp_f32 v247, v247
    v_pk_fma_f32 v[240:241], v[240:241], v[30:31], v[30:31]
    v_pk_fma_f32 v[242:243], v[242:243], v[30:31], v[30:31]
    v_pk_fma_f32 v[244:245], v[244:245], v[30:31], v[30:31]
    v_pk_fma_f32 v[246:247], v[246:247], v[30:31], v[30:31]
    v_rcp_f32 v240, v240
    v_rcp_f32 v241, v241
    v_rcp_f32 v242, v242
    v_rcp_f32 v243, v243
    v_rcp_f32 v244, v244
    v_rcp_f32 v245, v245
    v_rcp_f32 v246, v246
    v_rcp_f32 v247, v247
    v_pk_mul_f32 v[72:73], v[72:73], v[240:241]
    v_pk_mul_f32 v[74:75], v[74:75], v[242:243]
    v_pk_mul_f32 v[76:77], v[76:77], v[244:245]
    v_pk_mul_f32 v[78:79], v[78:79], v[246:247]
    v_cvt_pk_bf16_f32 v228, v72, v73
    v_cvt_pk_bf16_f32 v229, v74, v75
    v_cvt_pk_bf16_f32 v230, v76, v77
    v_cvt_pk_bf16_f32 v231, v78, v79
    buffer_store_dwordx4 v[228:231], v28, s[40:43], s36 offen offset:3072 sc1
    ds_read_b128 v[184:187], v4 offset:35712
    ds_read_b128 v[188:191], v4 offset:35744
    s_waitcnt lgkmcnt(2)
    v_pk_fma_f32 v[80:81], v[176:177], v[248:249], v[80:81]
    v_pk_fma_f32 v[82:83], v[178:179], v[248:249], v[82:83]
    v_pk_fma_f32 v[84:85], v[180:181], v[248:249], v[84:85]
    v_pk_fma_f32 v[86:87], v[182:183], v[248:249], v[86:87]
    v_pk_mul_f32 v[240:241], v[80:81], v[80:81]
    v_pk_mul_f32 v[242:243], v[82:83], v[82:83]
    v_pk_mul_f32 v[244:245], v[84:85], v[84:85]
    v_pk_mul_f32 v[246:247], v[86:87], v[86:87]
    v_pk_fma_f32 v[240:241], v[240:241], v[254:255], v[252:253]
    v_pk_fma_f32 v[242:243], v[242:243], v[254:255], v[252:253]
    v_pk_fma_f32 v[244:245], v[244:245], v[254:255], v[252:253]
    v_pk_fma_f32 v[246:247], v[246:247], v[254:255], v[252:253]
    v_pk_mul_f32 v[240:241], v[240:241], v[80:81]
    v_pk_mul_f32 v[242:243], v[242:243], v[82:83]
    v_pk_mul_f32 v[244:245], v[244:245], v[84:85]
    v_pk_mul_f32 v[246:247], v[246:247], v[86:87]
    v_exp_f32 v240, v240
    v_exp_f32 v241, v241
    v_exp_f32 v242, v242
    v_exp_f32 v243, v243
    v_exp_f32 v244, v244
    v_exp_f32 v245, v245
    v_exp_f32 v246, v246
    v_exp_f32 v247, v247
    v_pk_fma_f32 v[240:241], v[240:241], v[30:31], v[30:31]
    v_pk_fma_f32 v[242:243], v[242:243], v[30:31], v[30:31]
    v_pk_fma_f32 v[244:245], v[244:245], v[30:31], v[30:31]
    v_pk_fma_f32 v[246:247], v[246:247], v[30:31], v[30:31]
    v_rcp_f32 v240, v240
    v_rcp_f32 v241, v241
    v_rcp_f32 v242, v242
    v_rcp_f32 v243, v243
    v_rcp_f32 v244, v244
    v_rcp_f32 v245, v245
    v_rcp_f32 v246, v246
    v_rcp_f32 v247, v247
    v_pk_mul_f32 v[80:81], v[80:81], v[240:241]
    v_pk_mul_f32 v[82:83], v[82:83], v[242:243]
    v_pk_mul_f32 v[84:85], v[84:85], v[244:245]
    v_pk_mul_f32 v[86:87], v[86:87], v[246:247]
    v_cvt_pk_bf16_f32 v232, v80, v81
    v_cvt_pk_bf16_f32 v233, v82, v83
    v_cvt_pk_bf16_f32 v234, v84, v85
    v_cvt_pk_bf16_f32 v235, v86, v87
    buffer_store_dwordx4 v[232:235], v28, s[40:43], s55 offen offset:0 sc1
    s_waitcnt lgkmcnt(0)
    v_pk_fma_f32 v[88:89], v[184:185], v[248:249], v[88:89]
    v_pk_fma_f32 v[90:91], v[186:187], v[248:249], v[90:91]
    v_pk_fma_f32 v[92:93], v[188:189], v[248:249], v[92:93]
    v_pk_fma_f32 v[94:95], v[190:191], v[248:249], v[94:95]
    v_pk_mul_f32 v[240:241], v[88:89], v[88:89]
    v_pk_mul_f32 v[242:243], v[90:91], v[90:91]
    v_pk_mul_f32 v[244:245], v[92:93], v[92:93]
    v_pk_mul_f32 v[246:247], v[94:95], v[94:95]
    v_pk_fma_f32 v[240:241], v[240:241], v[254:255], v[252:253]
    v_pk_fma_f32 v[242:243], v[242:243], v[254:255], v[252:253]
    v_pk_fma_f32 v[244:245], v[244:245], v[254:255], v[252:253]
    v_pk_fma_f32 v[246:247], v[246:247], v[254:255], v[252:253]
    v_pk_mul_f32 v[240:241], v[240:241], v[88:89]
    v_pk_mul_f32 v[242:243], v[242:243], v[90:91]
    v_pk_mul_f32 v[244:245], v[244:245], v[92:93]
    v_pk_mul_f32 v[246:247], v[246:247], v[94:95]
    v_exp_f32 v240, v240
    v_exp_f32 v241, v241
    v_exp_f32 v242, v242
    v_exp_f32 v243, v243
    v_exp_f32 v244, v244
    v_exp_f32 v245, v245
    v_exp_f32 v246, v246
    v_exp_f32 v247, v247
    v_pk_fma_f32 v[240:241], v[240:241], v[30:31], v[30:31]
    v_pk_fma_f32 v[242:243], v[242:243], v[30:31], v[30:31]
    v_pk_fma_f32 v[244:245], v[244:245], v[30:31], v[30:31]
    v_pk_fma_f32 v[246:247], v[246:247], v[30:31], v[30:31]
    v_rcp_f32 v240, v240
    v_rcp_f32 v241, v241
    v_rcp_f32 v242, v242
    v_rcp_f32 v243, v243
    v_rcp_f32 v244, v244
    v_rcp_f32 v245, v245
    v_rcp_f32 v246, v246
    v_rcp_f32 v247, v247
    v_pk_mul_f32 v[88:89], v[88:89], v[240:241]
    v_pk_mul_f32 v[90:91], v[90:91], v[242:243]
    v_pk_mul_f32 v[92:93], v[92:93], v[244:245]
    v_pk_mul_f32 v[94:95], v[94:95], v[246:247]
    v_cvt_pk_bf16_f32 v236, v88, v89
    v_cvt_pk_bf16_f32 v237, v90, v91
    v_cvt_pk_bf16_f32 v238, v92, v93
    v_cvt_pk_bf16_f32 v239, v94, v95
    buffer_store_dwordx4 v[236:239], v28, s[40:43], s55 offen offset:1024 sc1
    s_add_u32 s34, s50, s53
    s_add_u32 s50, s50, 1
    s_cmp_eq_u32 s50, 22
    s_cselect_b32 s50, 0, s50
    s_lshl_b32 s37, s34, 14
    s_add_u32 s37, s37, 0x1980000
    buffer_load_dwordx4 v[104:107], v16, s[40:43], s37 offen sc1
    buffer_load_dwordx4 v[108:111], v17, s[40:43], s37 offen sc1
CH_NO2B:
    s_mul_i32 s34, s54, 98304
    s_add_u32 s34, s34, 0xc00000
    s_xor_b32 s35, s54, 1
    s_mul_i32 s35, s35, 98304
    s_add_u32 s35, s35, 0xc00000
    v_add_u32 v21, s34, v28
    v_add_u32 v22, s35, v28
    s_waitcnt vmcnt(2)
    s_mov_b64 exec, 1
    v_mov_b32 v4, 1
    ds_add_rtn_u32 v5, v25, v4 offset:35332
    s_add_u32 s35, s38, 16384
    s_waitcnt lgkmcnt(0)
    v_cmp_ne_u32 vcc, 3, v5
    s_cbranch_vccnz CH_S9
    s_mov_b64 exec, 15
    v_mov_b32 v4, 1
    v_lshlrev_b32 v5, 8, v1
    buffer_atomic_add v4, v5, s[40:43], s35 offen sc1
CH_S9:
    s_mov_b64 exec, -1
    s_setprio 0
    s_add_u32 s34, s50, s53
    s_add_u32 s50, s50, 1
    s_cmp_eq_u32 s50, 22
    s_cselect_b32 s50, 0, s50
    s_lshl_b32 s37, s34, 14
    s_add_u32 s37, s37, 0x1980000
    buffer_load_dwordx4 v[112:115], v16, s[40:43], s37 offen sc1
    buffer_load_dwordx4 v[116:119], v17, s[40:43], s37 offen sc1
    s_add_u32 s34, s50, s53
    s_add_u32 s50, s50, 1
    s_cmp_eq_u32 s50, 22
    s_cselect_b32 s50, 0, s50
    s_lshl_b32 s37, s34, 14
    s_add_u32 s37, s37, 0x1980000
    buffer_load_dwordx4 v[120:123], v16, s[40:43], s37 offen sc1
    buffer_load_dwordx4 v[124:127], v17, s[40:43], s37 offen sc1
    s_add_u32 s34, s50, s53
    s_add_u32 s50, s50, 1
    s_cmp_eq_u32 s50, 22
    s_cselect_b32 s50, 0, s50
    s_lshl_b32 s37, s34, 14
    s_add_u32 s37, s37, 0x1980000
    buffer_load_dwordx4 v[128:131], v16, s[40:43], s37 offen sc1
    buffer_load_dwordx4 v[132:135], v17, s[40:43], s37 offen sc1
    s_add_u32 s34, s50, s53
    s_add_u32 s50, s50, 1
    s_cmp_eq_u32 s50, 22
    s_cselect_b32 s50, 0, s50
    s_lshl_b32 s37, s34, 14
    s_add_u32 s37, s37, 0x1980000
    buffer_load_dwordx4 v[136:139], v16, s[40:43], s37 offen sc1
    buffer_load_dwordx4 v[140:143], v17, s[40:43], s37 offen sc1
    s_add_u32 s34, s50, s53
    s_add_u32 s50, s50, 1
    s_cmp_eq_u32 s50, 22
    s_cselect_b32 s50, 0, s50
    s_lshl_b32 s37, s34, 14
    s_add_u32 s37, s37, 0x1980000
    buffer_load_dwordx4 v[144:147], v16, s[40:43], s37 offen sc1
    buffer_load_dwordx4 v[148:151], v17, s[40:43], s37 offen sc1
    s_add_u32 s34, s50, s53
    s_add_u32 s50, s50, 1
    s_cmp_eq_u32 s50, 22
    s_cselect_b32 s50, 0, s50
    s_lshl_b32 s37, s34, 14
    s_add_u32 s37, s37, 0x1980000
    buffer_load_dwordx4 v[152:155], v16, s[40:43], s37 offen sc1
    buffer_load_dwordx4 v[156:159], v17, s[40:43], s37 offen sc1
    s_add_u32 s34, s50, s53
    s_add_u32 s50, s50, 1
    s_cmp_eq_u32 s50, 22
    s_cselect_b32 s50, 0, s50
    s_lshl_b32 s37, s34, 14
    s_add_u32 s37, s37, 0x1980000
    buffer_load_dwordx4 v[160:163], v16, s[40:43], s37 offen sc1
    buffer_load_dwordx4 v[164:167], v17, s[40:43], s37 offen sc1
    s_add_u32 s34, s50, s53
    s_add_u32 s50, s50, 1
    s_cmp_eq_u32 s50, 22
    s_cselect_b32 s50, 0, s50
    s_lshl_b32 s37, s34, 14
    s_add_u32 s37, s37, 0x1980000
    buffer_load_dwordx4 v[168:171], v16, s[40:43], s37 offen sc1
    buffer_load_dwordx4 v[172:175], v17, s[40:43], s37 offen sc1
    s_add_u32 s35, s57, 16384
    s_cmp_lg_u32 s29, 0
    s_cbranch_scc1 CH_Q10
    s_mov_b32 s34, 400000
    v_mov_b32 v12, 0
    s_mov_b64 exec, 1
CH_P10:
    buffer_atomic_umax v12, v25, s[40:43], s35 offen sc0 sc1
    s_sub_u32 s34, s34, 1
    s_cmp_eq_u32 s34, 0
    s_cbranch_scc1 CH_Q10
    s_waitcnt vmcnt(0)
    v_cmp_gt_u32 vcc, 16, v12
    s_cbranch_vccz CH_Q10
    s_sleep 4
    s_branch CH_P10
CH_Q10:
    s_mov_b64 exec, -1
    s_waitcnt vmcnt(0)
    v_add_u32 v11, 1, v11
    s_add_u32 s39, s39, 1
    s_waitcnt lgkmcnt(0)
    ds_write_b32 v9, v11 offset:34304
    s_mov_b32 s34, 400000
CH_W11:
    ds_read_b32 v12, v10 offset:34304
    s_sub_u32 s34, s34, 1
    s_cmp_eq_u32 s34, 0
    s_cbranch_scc1 CH_X11
    s_waitcnt lgkmcnt(0)
    v_cmp_gt_u32 vcc, s39, v12
    s_cbranch_vccz CH_X11
    s_sleep 2
    s_branch CH_W11
CH_X11:
    s_waitcnt lgkmcnt(0)
    s_add_u32 s34, s51, s53
    s_add_u32 s51, s51, 1
    s_cmp_eq_u32 s51, 22
    s_cselect_b32 s51, 0, s51
    s_lshl_b32 s35, s34, 10
    buffer_load_dwordx4 v[176:179], v21, s[40:43], s35 offen sc1
    buffer_load_dwordx4 v[180:183], v22, s[40:43], s35 offen sc1
    s_add_u32 s34, s51, s53
    s_add_u32 s51, s51, 1
    s_cmp_eq_u32 s51, 22
    s_cselect_b32 s51, 0, s51
    s_lshl_b32 s35, s34, 10
    buffer_load_dwordx4 v[184:187], v21, s[40:43], s35 offen sc1
    buffer_load_dwordx4 v[188:191], v22, s[40:43], s35 offen sc1
    s_add_u32 s34, s51, s53
    s_add_u32 s51, s51, 1
    s_cmp_eq_u32 s51, 22
    s_cselect_b32 s51, 0, s51
    s_lshl_b32 s35, s34, 10
    buffer_load_dwordx4 v[192:195], v21, s[40:43], s35 offen sc1
    buffer_load_dwordx4 v[196:199], v22, s[40:43], s35 offen sc1
    s_add_u32 s34, s51, s53
    s_add_u32 s51, s51, 1
    s_cmp_eq_u32 s51, 22
    s_cselect_b32 s51, 0, s51
    s_lshl_b32 s35, s34, 10
    buffer_load_dwordx4 v[200:203], v21, s[40:43], s35 offen sc1
    buffer_load_dwordx4 v[204:207], v22, s[40:43], s35 offen sc1
    s_add_u32 s34, s51, s53
    s_add_u32 s51, s51, 1
    s_cmp_eq_u32 s51, 22
    s_cselect_b32 s51, 0, s51
    s_lshl_b32 s35, s34, 10
    buffer_load_dwordx4 v[208:211], v21, s[40:43], s35 offen sc1
    buffer_load_dwordx4 v[212:215], v22, s[40:43], s35 offen sc1
    s_waitcnt vmcnt(8)
    v_mfma_f32_32x32x16_bf16 v[48:63], v[100:103], v[176:179], 0
    v_mfma_f32_32x32x16_bf16 v[64:79], v[96:99], v[180:183], 0
    v_mfma_f32_32x32x16_bf16 v[80:95], v[100:103], v[180:183], 0
    v_mfma_f32_32x32x16_bf16 v[32:47], v[96:99], v[176:179], v[32:47]
    s_add_u32 s34, s50, s53
    s_add_u32 s50, s50, 1
    s_cmp_eq_u32 s50, 22
    s_cselect_b32 s50, 0, s50
    s_lshl_b32 s37, s34, 14
    s_add_u32 s37, s37, 0x1980000
    buffer_load_dwordx4 v[96:99], v16, s[40:43], s37 offen sc1
    buffer_load_dwordx4 v[100:103], v17, s[40:43], s37 offen sc1
    s_add_u32 s34, s51, s53
    s_add_u32 s51, s51, 1
    s_cmp_eq_u32 s51, 22
    s_cselect_b32 s51, 0, s51
    s_lshl_b32 s35, s34, 10
    buffer_load_dwordx4 v[176:179], v21, s[40:43], s35 offen sc1
    buffer_load_dwordx4 v[180:183], v22, s[40:43], s35 offen sc1
    s_waitcnt vmcnt(10)
    v_mfma_f32_32x32x16_bf16 v[48:63], v[108:111], v[184:187], v[48:63]
    v_mfma_f32_32x32x16_bf16 v[64:79], v[104:107], v[188:191], v[64:79]
    v_mfma_f32_32x32x16_bf16 v[80:95], v[108:111], v[188:191], v[80:95]
    v_mfma_f32_32x32x16_bf16 v[32:47], v[104:107], v[184:187], v[32:47]
    s_add_u32 s34, s50, s53
    s_add_u32 s50, s50, 1
    s_cmp_eq_u32 s50, 22
    s_cselect_b32 s50, 0, s50
    s_lshl_b32 s37, s34, 14
    s_add_u32 s37, s37, 0x1980000
    buffer_load_dwordx4 v[104:107], v16, s[40:43], s37 offen sc1
    buffer_load_dwordx4 v[108:111], v17, s[40:43], s37 offen sc1
    s_add_u32 s34, s51, s53
    s_add_u32 s51, s51, 1
    s_cmp_eq_u32 s51, 22
    s_cselect_b32 s51, 0, s51
    s_lshl_b32 s35, s34, 10
    buffer_load_dwordx4 v[184:187], v21, s[40:43], s35 offen sc1
    buffer_load_dwordx4 v[188:191], v22, s[40:43], s35 offen sc1
    s_waitcnt vmcnt(12)
    v_mfma_f32_32x32x16_bf16 v[48:63], v[116:119], v[192:195], v[48:63]
    v_mfma_f32_32x32x16_bf16 v[64:79], v[112:115], v[196:199], v[64:79]
    v_mfma_f32_32x32x16_bf16 v[80:95], v[116:119], v[196:199], v[80:95]
    v_mfma_f32_32x32x16_bf16 v[32:47], v[112:115], v[192:195], v[32:47]
    s_add_u32 s34, s50, s53
    s_add_u32 s50, s50, 1
    s_cmp_eq_u32 s50, 22
    s_cselect_b32 s50, 0, s50
    s_lshl_b32 s37, s34, 14
    s_add_u32 s37, s37, 0x1980000
    buffer_load_dwordx4 v[112:115], v16, s[40:43], s37 offen sc1
    buffer_load_dwordx4 v[116:119], v17, s[40:43], s37 offen sc1
    s_add_u32 s34, s51, s53
    s_add_u32 s51, s51, 1
    s_cmp_eq_u32 s51, 22
    s_cselect_b32 s51, 0, s51
    s_lshl_b32 s35, s34, 10
    buffer_load_dwordx4 v[192:195], v21, s[40:43], s35 offen sc1
    buffer_load_dwordx4 v[196:199], v22, s[40:43], s35 offen sc1
    s_waitcnt vmcnt(14)
    v_mfma_f32_32x32x16_bf16 v[48:63], v[124:127], v[200:203], v[48:63]
    v_mfma_f32_32x32x16_bf16 v[64:79], v[120:123], v[204:207], v[64:79]
    v_mfma_f32_32x32x16_bf16 v[80:95], v[124:127], v[204:207], v[80:95]
    v_mfma_f32_32x32x16_bf16 v[32:47], v[120:123], v[200:203], v[32:47]
    s_add_u32 s34, s50, s53
    s_add_u32 s50, s50, 1
    s_cmp_eq_u32 s50, 22
    s_cselect_b32 s50, 0, s50
    s_lshl_b32 s37, s34, 14
    s_add_u32 s37, s37, 0x1980000
    buffer_load_dwordx4 v[120:123], v16, s[40:43], s37 offen sc1
    buffer_load_dwordx4 v[124:127], v17, s[40:43], s37 offen sc1
    s_add_u32 s34, s51, s53
    s_add_u32 s51, s51, 1
    s_cmp_eq_u32 s51, 22
    s_cselect_b32 s51, 0, s51
    s_lshl_b32 s35, s34, 10
    buffer_load_dwordx4 v[200:203], v21, s[40:43], s35 offen sc1
    buffer_load_dwordx4 v[204:207], v22, s[40:43], s35 offen sc1
    s_waitcnt vmcnt(16)
    v_mfma_f32_32x32x16_bf16 v[48:63], v[132:135], v[208:211], v[48:63]
    v_mfma_f32_32x32x16_bf16 v[64:79], v[128:131], v[212:215], v[64:79]
    v_mfma_f32_32x32x16_bf16 v[80:95], v[132:135], v[212:215], v[80:95]
    v_mfma_f32_32x32x16_bf16 v[32:47], v[128:131], v[208:211], v[32:47]
    s_add_u32 s34, s50, s53
    s_add_u32 s50, s50, 1
    s_cmp_eq_u32 s50, 22
    s_cselect_b32 s50, 0, s50
    s_lshl_b32 s37, s34, 14
    s_add_u32 s37, s37, 0x1980000
    buffer_load_dwordx4 v[128:131], v16, s[40:43], s37 offen sc1
    buffer_load_dwordx4 v[132:135], v17, s[40:43], s37 offen sc1
    s_add_u32 s34, s51, s53
    s_add_u32 s51, s51, 1
    s_cmp_eq_u32 s51, 22
    s_cselect_b32 s51, 0, s51
    s_lshl_b32 s35, s34, 10
    buffer_load_dwordx4 v[208:211], v21, s[40:43], s35 offen sc1
    buffer_load_dwordx4 v[212:215], v22, s[40:43], s35 offen sc1
    s_waitcnt vmcnt(16)
    v_mfma_f32_32x32x16_bf16 v[48:63], v[140:143], v[176:179], v[48:63]
    v_mfma_f32_32x32x16_bf16 v[64:79], v[136:139], v[180:183], v[64:79]
    v_mfma_f32_32x32x16_bf16 v[80:95], v[140:143], v[180:183], v[80:95]
    v_mfma_f32_32x32x16_bf16 v[32:47], v[136:139], v[176:179], v[32:47]
    s_add_u32 s34, s50, s53
    s_add_u32 s50, s50, 1
    s_cmp_eq_u32 s50, 22
    s_cselect_b32 s50, 0, s50
    s_lshl_b32 s37, s34, 14
    s_add_u32 s37, s37, 0x1980000
    buffer_load_dwordx4 v[136:139], v16, s[40:43], s37 offen sc1
    buffer_load_dwordx4 v[140:143], v17, s[40:43], s37 offen sc1
    s_add_u32 s34, s51, s53
    s_add_u32 s51, s51, 1
    s_cmp_eq_u32 s51, 22
    s_cselect_b32 s51, 0, s51
    s_lshl_b32 s35, s34, 10
    buffer_load_dwordx4 v[176:179], v21, s[40:43], s35 offen sc1
    buffer_load_dwordx4 v[180:183], v22, s[40:43], s35 offen sc1
    s_waitcnt vmcnt(16)
    v_mfma_f32_32x32x16_bf16 v[48:63], v[148:151], v[184:187], v[48:63]
    v_mfma_f32_32x32x16_bf16 v[64:79], v[144:147], v[188:191], v[64:79]
    v_mfma_f32_32x32x16_bf16 v[80:95], v[148:151], v[188:191], v[80:95]
    v_mfma_f32_32x32x16_bf16 v[32:47], v[144:147], v[184:187], v[32:47]
    s_add_u32 s34, s50, s53
    s_add_u32 s50, s50, 1
    s_cmp_eq_u32 s50, 22
    s_cselect_b32 s50, 0, s50
    s_lshl_b32 s37, s34, 14
    s_add_u32 s37, s37, 0x1980000
    buffer_load_dwordx4 v[144:147], v16, s[40:43], s37 offen sc1
    buffer_load_dwordx4 v[148:151], v17, s[40:43], s37 offen sc1
    s_add_u32 s34, s51, s53
    s_add_u32 s51, s51, 1
    s_cmp_eq_u32 s51, 22
    s_cselect_b32 s51, 0, s51
    s_lshl_b32 s35, s34, 10
    buffer_load_dwordx4 v[184:187], v21, s[40:43], s35 offen sc1
    buffer_load_dwordx4 v[188:191], v22, s[40:43], s35 offen sc1
    s_waitcnt vmcnt(16)
    v_mfma_f32_32x32x16_bf16 v[48:63], v[156:159], v[192:195], v[48:63]
    v_mfma_f32_32x32x16_bf16 v[64:79], v[152:155], v[196:199], v[64:79]
    v_mfma_f32_32x32x16_bf16 v[80:95], v[156:159], v[196:199], v[80:95]
    v_mfma_f32_32x32x16_bf16 v[32:47], v[152:155], v[192:195], v[32:47]
    s_add_u32 s34, s50, s53
    s_add_u32 s50, s50, 1
    s_cmp_eq_u32 s50, 22
    s_cselect_b32 s50, 0, s50
    s_lshl_b32 s37, s34, 14
    s_add_u32 s37, s37, 0x1980000
    buffer_load_dwordx4 v[152:155], v16, s[40:43], s37 offen sc1
    buffer_load_dwordx4 v[156:159], v17, s[40:43], s37 offen sc1
    s_add_u32 s34, s51, s53
    s_add_u32 s51, s51, 1
    s_cmp_eq_u32 s51, 22
    s_cselect_b32 s51, 0, s51
    s_lshl_b32 s35, s34, 10
    buffer_load_dwordx4 v[192:195], v21, s[40:43], s35 offen sc1
    buffer_load_dwordx4 v[196:199], v22, s[40:43], s35 offen sc1
    s_waitcnt vmcnt(16)
    v_mfma_f32_32x32x16_bf16 v[48:63], v[164:167], v[200:203], v[48:63]
    v_mfma_f32_32x32x16_bf16 v[64:79], v[160:163], v[204:207], v[64:79]
    v_mfma_f32_32x32x16_bf16 v[80:95], v[164:167], v[204:207], v[80:95]
    v_mfma_f32_32x32x16_bf16 v[32:47], v[160:163], v[200:203], v[32:47]
    s_add_u32 s34, s50, s53
    s_add_u32 s50, s50, 1
    s_cmp_eq_u32 s50, 22
    s_cselect_b32 s50, 0, s50
    s_lshl_b32 s37, s34, 14
    s_add_u32 s37, s37, 0x1980000
    buffer_load_dwordx4 v[160:163], v16, s[40:43], s37 offen sc1
    buffer_load_dwordx4 v[164:167], v17, s[40:43], s37 offen sc1
    s_add_u32 s34, s51, s53
    s_add_u32 s51, s51, 1
    s_cmp_eq_u32 s51, 22
    s_cselect_b32 s51, 0, s51
    s_lshl_b32 s35, s34, 10
    buffer_load_dwordx4 v[200:203], v21, s[40:43], s35 offen sc1
    buffer_load_dwordx4 v[204:207], v22, s[40:43], s35 offen sc1
    s_waitcnt vmcnt(16)
    v_mfma_f32_32x32x16_bf16 v[48:63], v[172:175], v[208:211], v[48:63]
    v_mfma_f32_32x32x16_bf16 v[64:79], v[168:171], v[212:215], v[64:79]
    v_mfma_f32_32x32x16_bf16 v[80:95], v[172:175], v[212:215], v[80:95]
    v_mfma_f32_32x32x16_bf16 v[32:47], v[168:171], v[208:211], v[32:47]
    s_add_u32 s34, s50, s53
    s_add_u32 s50, s50, 1
    s_cmp_eq_u32 s50, 22
    s_cselect_b32 s50, 0, s50
    s_lshl_b32 s37, s34, 14
    s_add_u32 s37, s37, 0x1980000
    buffer_load_dwordx4 v[168:171], v16, s[40:43], s37 offen sc1
    buffer_load_dwordx4 v[172:175], v17, s[40:43], s37 offen sc1
    s_add_u32 s34, s51, s53
    s_add_u32 s51, s51, 1
    s_cmp_eq_u32 s51, 22
    s_cselect_b32 s51, 0, s51
    s_lshl_b32 s35, s34, 10
    buffer_load_dwordx4 v[208:211], v21, s[40:43], s35 offen sc1
    buffer_load_dwordx4 v[212:215], v22, s[40:43], s35 offen sc1
    s_waitcnt vmcnt(16)
    v_mfma_f32_32x32x16_bf16 v[48:63], v[100:103], v[176:179], v[48:63]
    v_mfma_f32_32x32x16_bf16 v[64:79], v[96:99], v[180:183], v[64:79]
    v_mfma_f32_32x32x16_bf16 v[80:95], v[100:103], v[180:183], v[80:95]
    v_mfma_f32_32x32x16_bf16 v[32:47], v[96:99], v[176:179], v[32:47]
    s_add_u32 s34, s50, s53
    s_add_u32 s50, s50, 1
    s_cmp_eq_u32 s50, 22
    s_cselect_b32 s50, 0, s50
    s_lshl_b32 s37, s34, 14
    s_add_u32 s37, s37, 0x1980000
    buffer_load_dwordx4 v[96:99], v16, s[40:43], s37 offen sc1
    buffer_load_dwordx4 v[100:103], v17, s[40:43], s37 offen sc1
    s_add_u32 s34, s51, s53
    s_add_u32 s51, s51, 1
    s_cmp_eq_u32 s51, 22
    s_cselect_b32 s51, 0, s51
    s_lshl_b32 s35, s34, 10
    buffer_load_dwordx4 v[176:179], v21, s[40:43], s35 offen sc1
    buffer_load_dwordx4 v[180:183], v22, s[40:43], s35 offen sc1
    s_waitcnt vmcnt(16)
    v_mfma_f32_32x32x16_bf16 v[48:63], v[108:111], v[184:187], v[48:63]
    v_mfma_f32_32x32x16_bf16 v[64:79], v[104:107], v[188:191], v[64:79]
    v_mfma_f32_32x32x16_bf16 v[80:95], v[108:111], v[188:191], v[80:95]
    v_mfma_f32_32x32x16_bf16 v[32:47], v[104:107], v[184:187], v[32:47]
    s_add_u32 s34, s50, s53
    s_add_u32 s50, s50, 1
    s_cmp_eq_u32 s50, 22
    s_cselect_b32 s50, 0, s50
    s_lshl_b32 s37, s34, 14
    s_add_u32 s37, s37, 0x1980000
    buffer_load_dwordx4 v[104:107], v16, s[40:43], s37 offen sc1
    buffer_load_dwordx4 v[108:111], v17, s[40:43], s37 offen sc1
    s_mov_b32 s50, s56
    s_lshl_b32 s55, s32, 2
    s_add_u32 s55, s55, s29
    s_lshl_b32 s55, s55, 8
    s_add_u32 s55, s55, 0x1b08000
    v_mov_b32 v29, 0
    v_mov_b32 v8, 0
    s_and_b32 s50, s50, 7
    s_add_u32 s34, s50, s52
    s_add_u32 s50, s50, 1
    s_lshl_b32 s37, s34, 14
    s_add_u32 s37, s37, 0x1780000
    buffer_load_dwordx4 v[240:243], v16, s[40:43], s37 offen sc1
    buffer_load_dwordx4 v[244:247], v17, s[40:43], s37 offen sc1
    s_add_u32 s34, s51, s53
    s_add_u32 s51, s51, 1
    s_cmp_eq_u32 s51, 22
    s_cselect_b32 s51, 0, s51
    s_lshl_b32 s35, s34, 10
    buffer_load_dwordx4 v[184:187], v21, s[40:43], s35 offen sc1
    buffer_load_dwordx4 v[188:191], v22, s[40:43], s35 offen sc1
    s_waitcnt vmcnt(18)
    v_mfma_f32_32x32x16_bf16 v[48:63], v[116:119], v[192:195], v[48:63]
    v_mfma_f32_32x32x16_bf16 v[64:79], v[112:115], v[196:199], v[64:79]
    v_mfma_f32_32x32x16_bf16 v[80:95], v[116:119], v[196:199], v[80:95]
    v_mfma_f32_32x32x16_bf16 v[32:47], v[112:115], v[192:195], v[32:47]
    s_and_b32 s50, s50, 7
    s_add_u32 s34, s50, s52
    s_add_u32 s50, s50, 1
    s_lshl_b32 s37, s34, 14
    s_add_u32 s37, s37, 0x1780000
    buffer_load_dwordx4 v[112:115], v16, s[40:43], s37 offen sc1
    buffer_load_dwordx4 v[116:119], v17, s[40:43], s37 offen sc1
    s_add_u32 s34, s51, s53
    s_add_u32 s51, s51, 1
    s_cmp_eq_u32 s51, 22
    s_cselect_b32 s51, 0, s51
    s_lshl_b32 s35, s34, 10
    buffer_load_dwordx4 v[192:195], v21, s[40:43], s35 offen sc1
    buffer_load_dwordx4 v[196:199], v22, s[40:43], s35 offen sc1
    s_waitcnt vmcnt(18)
    v_mfma_f32_32x32x16_bf16 v[48:63], v[124:127], v[200:203], v[48:63]
    v_mfma_f32_32x32x16_bf16 v[64:79], v[120:123], v[204:207], v[64:79]
    v_mfma_f32_32x32x16_bf16 v[80:95], v[124:127], v[204:207], v[80:95]
    v_mfma_f32_32x32x16_bf16 v[32:47], v[120:123], v[200:203], v[32:47]
    s_and_b32 s50, s50, 7
    s_add_u32 s34, s50, s52
    s_add_u32 s50, s50, 1
    s_lshl_b32 s37, s34, 14
    s_add_u32 s37, s37, 0x1780000
    buffer_load_dwordx4 v[120:123], v16, s[40:43], s37 offen sc1
    buffer_load_dwordx4 v[124:127], v17, s[40:43], s37 offen sc1
    s_add_u32 s34, s51, s53
    s_add_u32 s51, s51, 1
    s_cmp_eq_u32 s51, 22
    s_cselect_b32 s51, 0, s51
    s_lshl_b32 s35, s34, 10
    buffer_load_dwordx4 v[200:203], v21, s[40:43], s35 offen sc1
    buffer_load_dwordx4 v[204:207], v22, s[40:43], s35 offen sc1
    s_waitcnt vmcnt(18)
    v_mfma_f32_32x32x16_bf16 v[48:63], v[132:135], v[208:211], v[48:63]
    v_mfma_f32_32x32x16_bf16 v[64:79], v[128:131], v[212:215], v[64:79]
    v_mfma_f32_32x32x16_bf16 v[80:95], v[132:135], v[212:215], v[80:95]
    v_mfma_f32_32x32x16_bf16 v[32:47], v[128:131], v[208:211], v[32:47]
    s_and_b32 s50, s50, 7
    s_add_u32 s34, s50, s52
    s_add_u32 s50, s50, 1
    s_lshl_b32 s37, s34, 14
    s_add_u32 s37, s37, 0x1780000
    buffer_load_dwordx4 v[128:131], v16, s[40:43], s37 offen sc1
    buffer_load_dwordx4 v[132:135], v17, s[40:43], s37 offen sc1
    s_add_u32 s34, s51, s53
    s_add_u32 s51, s51, 1
    s_cmp_eq_u32 s51, 22
    s_cselect_b32 s51, 0, s51
    s_lshl_b32 s35, s34, 10
    buffer_load_dwordx4 v[208:211], v21, s[40:43], s35 offen sc1
    buffer_load_dwordx4 v[212:215], v22, s[40:43], s35 offen sc1
    s_waitcnt vmcnt(18)
    v_mfma_f32_32x32x16_bf16 v[48:63], v[140:143], v[176:179], v[48:63]
    v_mfma_f32_32x32x16_bf16 v[64:79], v[136:139], v[180:183], v[64:79]
    v_mfma_f32_32x32x16_bf16 v[80:95], v[140:143], v[180:183], v[80:95]
    v_mfma_f32_32x32x16_bf16 v[32:47], v[136:139], v[176:179], v[32:47]
    s_and_b32 s50, s50, 7
    s_add_u32 s34, s50, s52
    s_add_u32 s50, s50, 1
    s_lshl_b32 s37, s34, 14
    s_add_u32 s37, s37, 0x1780000
    buffer_load_dwordx4 v[136:139], v16, s[40:43], s37 offen sc1
    buffer_load_dwordx4 v[140:143], v17, s[40:43], s37 offen sc1
    s_add_u32 s34, s51, s53
    s_add_u32 s51, s51, 1
    s_cmp_eq_u32 s51, 22
    s_cselect_b32 s51, 0, s51
    s_lshl_b32 s35, s34, 10
    buffer_load_dwordx4 v[176:179], v21, s[40:43], s35 offen sc1
    buffer_load_dwordx4 v[180:183], v22, s[40:43], s35 offen sc1
    s_waitcnt vmcnt(16)
    v_mfma_f32_32x32x16_bf16 v[48:63], v[148:151], v[184:187], v[48:63]
    v_mfma_f32_32x32x16_bf16 v[64:79], v[144:147], v[188:191], v[64:79]
    v_mfma_f32_32x32x16_bf16 v[80:95], v[148:151], v[188:191], v[80:95]
    v_mfma_f32_32x32x16_bf16 v[32:47], v[144:147], v[184:187], v[32:47]
    s_and_b32 s50, s50, 7
    s_add_u32 s34, s50, s52
    s_add_u32 s50, s50, 1
    s_lshl_b32 s37, s34, 14
    s_add_u32 s37, s37, 0x1780000
    buffer_load_dwordx4 v[144:147], v16, s[40:43], s37 offen sc1
    buffer_load_dwordx4 v[148:151], v17, s[40:43], s37 offen sc1
    s_add_u32 s34, s51, s53
    s_add_u32 s51, s51, 1
    s_cmp_eq_u32 s51, 22
    s_cselect_b32 s51, 0, s51
    s_lshl_b32 s35, s34, 10
    buffer_load_dwordx4 v[184:187], v21, s[40:43], s35 offen sc1
    buffer_load_dwordx4 v[188:191], v22, s[40:43], s35 offen sc1
    s_waitcnt vmcnt(16)
    v_mfma_f32_32x32x16_bf16 v[48:63], v[156:159], v[192:195], v[48:63]
    v_mfma_f32_32x32x16_bf16 v[64:79], v[152:155], v[196:199], v[64:79]
    v_mfma_f32_32x32x16_bf16 v[80:95], v[156:159], v[196:199], v[80:95]
    v_mfma_f32_32x32x16_bf16 v[32:47], v[152:155], v[192:195], v[32:47]
    s_and_b32 s50, s50, 7
    s_add_u32 s34, s50, s52
    s_add_u32 s50, s50, 1
    s_lshl_b32 s37, s34, 14
    s_add_u32 s37, s37, 0x1780000
    buffer_load_dwordx4 v[152:155], v16, s[40:43], s37 offen sc1
    buffer_load_dwordx4 v[156:159], v17, s[40:43], s37 offen sc1
    s_waitcnt vmcnt(14)
    v_mfma_f32_32x32x16_bf16 v[48:63], v[164:167], v[200:203], v[48:63]
    v_mfma_f32_32x32x16_bf16 v[64:79], v[160:163], v[204:207], v[64:79]
    v_mfma_f32_32x32x16_bf16 v[80:95], v[164:167], v[204:207], v[80:95]
    v_mfma_f32_32x32x16_bf16 v[32:47], v[160:163], v[200:203], v[32:47]
    s_and_b32 s50, s50, 7
    s_add_u32 s34, s50, s52
    s_add_u32 s50, s50, 1
    s_lshl_b32 s37, s34, 14
    s_add_u32 s37, s37, 0x1780000
    buffer_load_dwordx4 v[160:163], v16, s[40:43], s37 offen sc1
    buffer_load_dwordx4 v[164:167], v17, s[40:43], s37 offen sc1
    s_mov_b32 s34, 400000
CH_HL:
    s_mov_b64 exec, 1
    buffer_atomic_umax v29, v25, s[40:43], s55 offen sc0 sc1
    s_mov_b64 exec, -1
    s_mov_b32 s35, 6
CH_HI:
    ds_read_b32 v12, v9 offset:33280
    s_waitcnt lgkmcnt(0)
    v_cmp_gt_u32 vcc, 18, v12
    s_cbranch_vccz CH_HX
    s_sub_u32 s35, s35, 1
    s_cmp_lg_u32 s35, 0
    s_cbranch_scc1 CH_HI
    s_waitcnt vmcnt(0)
    s_sub_u32 s34, s34, 1
    s_cmp_lg_u32 s34, 0
    s_cbranch_scc1 CH_HL
CH_HX:
    s_setprio 2
    s_mov_b64 exec, 1
    buffer_atomic_umax v8, v25, s[40:43], s55 offen sc0 sc1
    s_mov_b64 exec, -1
    s_waitcnt vmcnt(14)
    v_mfma_f32_32x32x16_bf16 v[48:63], v[172:175], v[208:211], v[48:63]
    v_mfma_f32_32x32x16_bf16 v[64:79], v[168:171], v[212:215], v[64:79]
    v_mfma_f32_32x32x16_bf16 v[80:95], v[172:175], v[212:215], v[80:95]
    v_mfma_f32_32x32x16_bf16 v[32:47], v[168:171], v[208:211], v[32:47]
    s_waitcnt vmcnt(10)
    v_mfma_f32_32x32x16_bf16 v[48:63], v[100:103], v[176:179], v[48:63]
    v_mfma_f32_32x32x16_bf16 v[64:79], v[96:99], v[180:183], v[64:79]
    v_mfma_f32_32x32x16_bf16 v[80:95], v[100:103], v[180:183], v[80:95]
    v_mfma_f32_32x32x16_bf16 v[32:47], v[96:99], v[176:179], v[32:47]
    s_waitcnt vmcnt(6)
    v_mfma_f32_32x32x16_bf16 v[48:63], v[108:111], v[184:187], v[48:63]
    v_mfma_f32_32x32x16_bf16 v[64:79], v[104:107], v[188:191], v[64:79]
    v_mfma_f32_32x32x16_bf16 v[80:95], v[108:111], v[188:191], v[80:95]
    v_mfma_f32_32x32x16_bf16 v[32:47], v[104:107], v[184:187], v[32:47]
    s_lshl_b32 s34, s54, 15
    s_add_u32 s34, s34, 0xa00000
    v_add_u32 v21, s34, v28
    v_xor_b32 v22, 0x8000, v21
    s_waitcnt vmcnt(1)
    v_readfirstlane_b32 s34, v29
    s_nop 0
    s_cmp_ge_u32 s34, 8
    s_cbranch_scc1 CH_OGO
    s_waitcnt vmcnt(0)
    v_mov_b32 v29, v8
    s_nop 0
    v_readfirstlane_b32 s34, v29
    s_mov_b32 s35, s55
    s_cmp_ge_u32 s34, 8
    s_cbranch_scc1 CH_OGO
    s_mov_b32 s34, 400000
CH_W12:
    s_sleep 8
    ds_read_b32 v12, v10 offset:33280
    s_sub_u32 s34, s34, 1
    s_cmp_eq_u32 s34, 0
    s_cbranch_scc1 CH_X12
    s_waitcnt lgkmcnt(0)
    v_cmp_gt_u32 vcc, 17, v12
    s_cbranch_vccnz CH_W12
CH_X12:
    s_waitcnt lgkmcnt(0)
    s_mov_b32 s34, 400000
    v_mov_b32 v12, 0
    v_mov_b32 v29, 0
    v_mov_b32 v5, 0
    s_mov_b64 exec, 1
    buffer_atomic_umax v12, v25, s[40:43], s35 offen sc0 sc1
    s_sleep 5
    buffer_atomic_umax v29, v25, s[40:43], s35 offen sc0 sc1
    s_sleep 5
CH_P13:
    buffer_atomic_umax v5, v25, s[40:43], s35 offen sc0 sc1
    s_sub_u32 s34, s34, 1
    s_cmp_eq_u32 s34, 0
    s_cbranch_scc1 CH_Q13
    s_waitcnt vmcnt(2)
    v_cmp_gt_u32 vcc, 8, v12
    s_cbranch_vccz CH_Q13
    buffer_atomic_umax v12, v25, s[40:43], s35 offen sc0 sc1
    s_waitcnt vmcnt(2)
    v_cmp_gt_u32 vcc, 8, v29
    s_cbranch_vccz CH_Q13
    buffer_atomic_umax v29, v25, s[40:43], s35 offen sc0 sc1
    s_waitcnt vmcnt(2)
    v_cmp_gt_u32 vcc, 8, v5
    s_cbranch_vccz CH_Q13
    s_branch CH_P13
CH_Q13:
    s_mov_b64 exec, -1
CH_OGO:
    s_setprio 2
    s_mov_b32 s36, 400000
    s_add_u32 s50, s56, 0
    s_and_b32 s50, s50, 7
    s_add_u32 s34, s50, s52
    s_add_u32 s50, s50, 1
    s_lshl_b32 s35, s34, 10
    buffer_load_dwordx4 v[176:179], v21, s[40:43], s35 offen sc1
    buffer_load_dwordx4 v[180:183], v22, s[40:43], s35 offen sc1
    s_and_b32 s50, s50, 7
    s_add_u32 s34, s50, s52
    s_add_u32 s50, s50, 1
    s_lshl_b32 s35, s34, 10
    buffer_load_dwordx4 v[184:187], v21, s[40:43], s35 offen sc1
    buffer_load_dwordx4 v[188:191], v22, s[40:43], s35 offen sc1
    s_and_b32 s50, s50, 7
    s_add_u32 s34, s50, s52
    s_add_u32 s50, s50, 1
    s_lshl_b32 s35, s34, 10
    buffer_load_dwordx4 v[192:195], v21, s[40:43], s35 offen sc1
    buffer_load_dwordx4 v[196:199], v22, s[40:43], s35 offen sc1
    s_and_b32 s50, s50, 7
    s_add_u32 s34, s50, s52
    s_add_u32 s50, s50, 1
    s_lshl_b32 s35, s34, 10
    buffer_load_dwordx4 v[200:203], v21, s[40:43], s35 offen sc1
    buffer_load_dwordx4 v[204:207], v22, s[40:43], s35 offen sc1
    s_and_b32 s50, s50, 7
    s_add_u32 s34, s50, s52
    s_add_u32 s50, s50, 1
    s_lshl_b32 s35, s34, 10
    buffer_load_dwordx4 v[208:211], v21, s[40:43], s35 offen sc1
    buffer_load_dwordx4 v[212:215], v22, s[40:43], s35 offen sc1
    s_and_b32 s50, s50, 7
    s_add_u32 s34, s50, s52
    s_add_u32 s50, s50, 1
    s_lshl_b32 s35, s34, 10
    buffer_load_dwordx4 v[216:219], v21, s[40:43], s35 offen sc1
    buffer_load_dwordx4 v[220:223], v22, s[40:43], s35 offen sc1
    s_and_b32 s50, s50, 7
    s_add_u32 s34, s50, s52
    s_add_u32 s50, s50, 1
    s_lshl_b32 s35, s34, 10
    buffer_load_dwordx4 v[224:227], v21, s[40:43], s35 offen sc1
    buffer_load_dwordx4 v[228:231], v22, s[40:43], s35 offen sc1
    s_and_b32 s50, s50, 7
    s_add_u32 s34, s50, s52
    s_add_u32 s50, s50, 1
    s_lshl_b32 s35, s34, 10
    buffer_load_dwordx4 v[232:235], v21, s[40:43], s35 offen sc1
    buffer_load_dwordx4 v[236:239], v22, s[40:43], s35 offen sc1
CH_O0:
    s_waitcnt vmcnt(14)
    v_max3_u32 v4, v176, v177, v178
    v_max3_u32 v5, v179, v180, v181
    v_max3_u32 v4, v4, v182, v183
    v_max_u32 v4, v4, v5
    v_cmp_eq_u32 vcc, -1, v4
    s_cbranch_vccnz CH_R0
CH_G0:
    v_mfma_f32_32x32x16_bf16 v[48:63], v[244:247], v[176:179], v[48:63]
    v_mfma_f32_32x32x16_bf16 v[64:79], v[240:243], v[180:183], v[64:79]
    v_mfma_f32_32x32x16_bf16 v[80:95], v[244:247], v[180:183], v[80:95]
    v_mfma_f32_32x32x16_bf16 v[32:47], v[240:243], v[176:179], v[32:47]
CH_O1:
    s_waitcnt vmcnt(12)
    v_max3_u32 v4, v184, v185, v186
    v_max3_u32 v5, v187, v188, v189
    v_max3_u32 v4, v4, v190, v191
    v_max_u32 v4, v4, v5
    v_cmp_eq_u32 vcc, -1, v4
    s_cbranch_vccnz CH_R1
CH_G1:
    v_mfma_f32_32x32x16_bf16 v[48:63], v[116:119], v[184:187], v[48:63]
    v_mfma_f32_32x32x16_bf16 v[64:79], v[112:115], v[188:191], v[64:79]
    v_mfma_f32_32x32x16_bf16 v[80:95], v[116:119], v[188:191], v[80:95]
    v_mfma_f32_32x32x16_bf16 v[32:47], v[112:115], v[184:187], v[32:47]
CH_O2:
    s_waitcnt vmcnt(10)
    v_max3_u32 v4, v192, v193, v194
    v_max3_u32 v5, v195, v196, v197
    v_max3_u32 v4, v4, v198, v199
    v_max_u32 v4, v4, v5
    v_cmp_eq_u32 vcc, -1, v4
    s_cbranch_vccnz CH_R2
CH_G2:
    v_mfma_f32_32x32x16_bf16 v[48:63], v[124:127], v[192:195], v[48:63]
    v_mfma_f32_32x32x16_bf16 v[64:79], v[120:123], v[196:199], v[64:79]
    v_mfma_f32_32x32x16_bf16 v[80:95], v[124:127], v[196:199], v[80:95]
    v_mfma_f32_32x32x16_bf16 v[32:47], v[120:123], v[192:195], v[32:47]
CH_O3:
    s_waitcnt vmcnt(8)
    v_max3_u32 v4, v200, v201, v202
    v_max3_u32 v5, v203, v204, v205
    v_max3_u32 v4, v4, v206, v207
    v_max_u32 v4, v4, v5
    v_cmp_eq_u32 vcc, -1, v4
    s_cbranch_vccnz CH_R3
CH_G3:
    v_mfma_f32_32x32x16_bf16 v[48:63], v[132:135], v[200:203], v[48:63]
    v_mfma_f32_32x32x16_bf16 v[64:79], v[128:131], v[204:207], v[64:79]
    v_mfma_f32_32x32x16_bf16 v[80:95], v[132:135], v[204:207], v[80:95]
    v_mfma_f32_32x32x16_bf16 v[32:47], v[128:131], v[200:203], v[32:47]
CH_O4:
    s_waitcnt vmcnt(6)
    v_max3_u32 v4, v208, v209, v210
    v_max3_u32 v5, v211, v212, v213
    v_max3_u32 v4, v4, v214, v215
    v_max_u32 v4, v4, v5
    v_cmp_eq_u32 vcc, -1, v4
    s_cbranch_vccnz CH_R4
CH_G4:
    v_mfma_f32_32x32x16_bf16 v[48:63], v[140:143], v[208:211], v[48:63]
    v_mfma_f32_32x32x16_bf16 v[64:79], v[136:139], v[212:215], v[64:79]
    v_mfma_f32_32x32x16_bf16 v[80:95], v[140:143], v[212:215], v[80:95]
    v_mfma_f32_32x32x16_bf16 v[32:47], v[136:139], v[208:211], v[32:47]
CH_O5:
    s_waitcnt vmcnt(4)
    v_max3_u32 v4, v216, v217, v218
    v_max3_u32 v5, v219, v220, v221
    v_max3_u32 v4, v4, v222, v223
    v_max_u32 v4, v4, v5
    v_cmp_eq_u32 vcc, -1, v4
    s_cbranch_vccnz CH_R5
CH_G5:
    v_mfma_f32_32x32x16_bf16 v[48:63], v[148:151], v[216:219], v[48:63]
    v_mfma_f32_32x32x16_bf16 v[64:79], v[144:147], v[220:223], v[64:79]
    v_mfma_f32_32x32x16_bf16 v[80:95], v[148:151], v[220:223], v[80:95]
    v_mfma_f32_32x32x16_bf16 v[32:47], v[144:147], v[216:219], v[32:47]
CH_O6:
    s_waitcnt vmcnt(2)
    v_max3_u32 v4, v224, v225, v226
    v_max3_u32 v5, v227, v228, v229
    v_max3_u32 v4, v4, v230, v231
    v_max_u32 v4, v4, v5
    v_cmp_eq_u32 vcc, -1, v4
    s_cbranch_vccnz CH_R6
CH_G6:
    v_mfma_f32_32x32x16_bf16 v[48:63], v[156:159], v[224:227], v[48:63]
    v_mfma_f32_32x32x16_bf16 v[64:79], v[152:155], v[228:231], v[64:79]
    v_mfma_f32_32x32x16_bf16 v[80:95], v[156:159], v[228:231], v[80:95]
    v_mfma_f32_32x32x16_bf16 v[32:47], v[152:155], v[224:227], v[32:47]
CH_O7:
    s_waitcnt vmcnt(0)
    v_max3_u32 v4, v232, v233, v234
    v_max3_u32 v5, v235, v236, v237
    v_max3_u32 v4, v4, v238, v239
    v_max_u32 v4, v4, v5
    v_cmp_eq_u32 vcc, -1, v4
    s_cbranch_vccnz CH_R7
CH_G7:
    v_mfma_f32_32x32x16_bf16 v[48:63], v[164:167], v[232:235], v[48:63]
    v_mfma_f32_32x32x16_bf16 v[64:79], v[160:163], v[236:239], v[64:79]
    v_mfma_f32_32x32x16_bf16 v[80:95], v[164:167], v[236:239], v[80:95]
    v_mfma_f32_32x32x16_bf16 v[32:47], v[160:163], v[232:235], v[32:47]
    s_nop 8
    ds_write_b128 v14, v[48:51] offset:0
    ds_write_b128 v14, v[52:55] offset:1024
    ds_write_b128 v14, v[56:59] offset:2048
    ds_write_b128 v14, v[60:63] offset:3072
    ds_write_b128 v14, v[64:67] offset:4096
    ds_write_b128 v14, v[68:71] offset:5120
    ds_write_b128 v14, v[72:75] offset:6144
    ds_write_b128 v14, v[76:79] offset:7168
    ds_write_b128 v14, v[80:83] offset:8192
    ds_write_b128 v14, v[84:87] offset:9216
    ds_write_b128 v14, v[88:91] offset:10240
    ds_write_b128 v14, v[92:95] offset:11264
    s_setprio 2
    v_add_u32 v11, 1, v11
    s_add_u32 s39, s39, 1
    s_waitcnt lgkmcnt(0)
    ds_write_b32 v9, v11 offset:34304
    s_mov_b32 s34, 400000
CH_W14:
    ds_read_b32 v12, v10 offset:34304
    s_sub_u32 s34, s34, 1
    s_cmp_eq_u32 s34, 0
    s_cbranch_scc1 CH_X14
    s_waitcnt lgkmcnt(0)
    v_cmp_gt_u32 vcc, s39, v12
    s_cbranch_vccnz CH_W14
CH_X14:
    s_waitcnt lgkmcnt(0)
    ds_read_b128 v[48:51], v18 offset:0
    ds_read_b128 v[52:55], v18 offset:1024
    ds_read_b128 v[56:59], v18 offset:2048
    ds_read_b128 v[60:63], v18 offset:3072
    ds_read_b128 v[64:67], v19 offset:0
    ds_read_b128 v[68:71], v19 offset:1024
    ds_read_b128 v[72:75], v19 offset:2048
    ds_read_b128 v[76:79], v19 offset:3072
    ds_read_b128 v[80:83], v20 offset:0
    ds_read_b128 v[84:87], v20 offset:1024
    ds_read_b128 v[88:91], v20 offset:2048
    ds_read_b128 v[92:95], v20 offset:3072
    s_waitcnt lgkmcnt(8)
    v_pk_add_f32 v[32:33], v[32:33], v[48:49]
    v_pk_add_f32 v[34:35], v[34:35], v[50:51]
    v_pk_add_f32 v[36:37], v[36:37], v[52:53]
    v_pk_add_f32 v[38:39], v[38:39], v[54:55]
    v_pk_add_f32 v[40:41], v[40:41], v[56:57]
    v_pk_add_f32 v[42:43], v[42:43], v[58:59]
    v_pk_add_f32 v[44:45], v[44:45], v[60:61]
    v_pk_add_f32 v[46:47], v[46:47], v[62:63]
    s_waitcnt lgkmcnt(4)
    v_pk_add_f32 v[32:33], v[32:33], v[64:65]
    v_pk_add_f32 v[34:35], v[34:35], v[66:67]
    v_pk_add_f32 v[36:37], v[36:37], v[68:69]
    v_pk_add_f32 v[38:39], v[38:39], v[70:71]
    v_pk_add_f32 v[40:41], v[40:41], v[72:73]
    v_pk_add_f32 v[42:43], v[42:43], v[74:75]
    v_pk_add_f32 v[44:45], v[44:45], v[76:77]
    v_pk_add_f32 v[46:47], v[46:47], v[78:79]
    s_waitcnt lgkmcnt(0)
    v_pk_add_f32 v[32:33], v[32:33], v[80:81]
    v_pk_add_f32 v[34:35], v[34:35], v[82:83]
    v_pk_add_f32 v[36:37], v[36:37], v[84:85]
    v_pk_add_f32 v[38:39], v[38:39], v[86:87]
    v_pk_add_f32 v[40:41], v[40:41], v[88:89]
    v_pk_add_f32 v[42:43], v[42:43], v[90:91]
    v_pk_add_f32 v[44:45], v[44:45], v[92:93]
    v_pk_add_f32 v[46:47], v[46:47], v[94:95]
    v_cvt_pk_bf16_f32 v120, v32, v33
    v_cvt_pk_bf16_f32 v121, v34, v35
    v_cvt_pk_bf16_f32 v122, v36, v37
    v_cvt_pk_bf16_f32 v123, v38, v39
    v_cvt_pk_bf16_f32 v124, v40, v41
    v_cvt_pk_bf16_f32 v125, v42, v43
    v_cvt_pk_bf16_f32 v126, v44, v45
    v_cvt_pk_bf16_f32 v127, v46, v47
    v_permlane32_swap_b32 v120, v122
    v_permlane32_swap_b32 v121, v123
    v_permlane32_swap_b32 v124, v126
    v_permlane32_swap_b32 v125, v127
    buffer_store_dwordx4 v[120:123], v23, s[44:47], 0 offen offset:0
    buffer_store_dwordx4 v[124:127], v23, s[44:47], 0 offen offset:32
    s_endpgm
CH_R0:
    s_cmp_eq_u32 s36, 0
    s_cbranch_scc1 CH_G0
    s_sub_u32 s36, s36, 1
    s_setprio 0
    s_sleep 2
    s_cmp_gt_u32 s36, 399992
    s_cbranch_scc1 CH_RR0
    s_add_u32 s50, s56, 0
    s_and_b32 s50, s50, 7
    s_add_u32 s34, s50, s52
    s_add_u32 s50, s50, 1
    s_lshl_b32 s35, s34, 10
    s_mov_b32 exec_lo, 0x01010101
    s_mov_b32 exec_hi, 0x01010101
    buffer_atomic_or v25, v21, s[40:43], s35 offen sc1
    buffer_atomic_or v25, v22, s[40:43], s35 offen sc1
    s_mov_b64 exec, -1
    s_waitcnt vmcnt(0)
    s_sleep 16
CH_RR0:
    s_add_u32 s50, s56, 0
    s_and_b32 s50, s50, 7
    s_add_u32 s34, s50, s52
    s_add_u32 s50, s50, 1
    s_lshl_b32 s35, s34, 10
    buffer_load_dwordx4 v[176:179], v21, s[40:43], s35 offen sc1
    buffer_load_dwordx4 v[180:183], v22, s[40:43], s35 offen sc1
    s_and_b32 s50, s50, 7
    s_add_u32 s34, s50, s52
    s_add_u32 s50, s50, 1
    s_lshl_b32 s35, s34, 10
    buffer_load_dwordx4 v[184:187], v21, s[40:43], s35 offen sc1
    buffer_load_dwordx4 v[188:191], v22, s[40:43], s35 offen sc1
    s_and_b32 s50, s50, 7
    s_add_u32 s34, s50, s52
    s_add_u32 s50, s50, 1
    s_lshl_b32 s35, s34, 10
    buffer_load_dwordx4 v[192:195], v21, s[40:43], s35 offen sc1
    buffer_load_dwordx4 v[196:199], v22, s[40:43], s35 offen sc1
    s_and_b32 s50, s50, 7
    s_add_u32 s34, s50, s52
    s_add_u32 s50, s50, 1
    s_lshl_b32 s35, s34, 10
    buffer_load_dwordx4 v[200:203], v21, s[40:43], s35 offen sc1
    buffer_load_dwordx4 v[204:207], v22, s[40:43], s35 offen sc1
    s_and_b32 s50, s50, 7
    s_add_u32 s34, s50, s52
    s_add_u32 s50, s50, 1
    s_lshl_b32 s35, s34, 10
    buffer_load_dwordx4 v[208:211], v21, s[40:43], s35 offen sc1
    buffer_load_dwordx4 v[212:215], v22, s[40:43], s35 offen sc1
    s_and_b32 s50, s50, 7
    s_add_u32 s34, s50, s52
    s_add_u32 s50, s50, 1
    s_lshl_b32 s35, s34, 10
    buffer_load_dwordx4 v[216:219], v21, s[40:43], s35 offen sc1
    buffer_load_dwordx4 v[220:223], v22, s[40:43], s35 offen sc1
    s_and_b32 s50, s50, 7
    s_add_u32 s34, s50, s52
    s_add_u32 s50, s50, 1
    s_lshl_b32 s35, s34, 10
    buffer_load_dwordx4 v[224:227], v21, s[40:43], s35 offen sc1
    buffer_load_dwordx4 v[228:231], v22, s[40:43], s35 offen sc1
    s_and_b32 s50, s50, 7
    s_add_u32 s34, s50, s52
    s_add_u32 s50, s50, 1
    s_lshl_b32 s35, s34, 10
    buffer_load_dwordx4 v[232:235], v21, s[40:43], s35 offen sc1
    buffer_load_dwordx4 v[236:239], v22, s[40:43], s35 offen sc1
    s_branch CH_O0
CH_R1:
    s_cmp_eq_u32 s36, 0
    s_cbranch_scc1 CH_G1
    s_sub_u32 s36, s36, 1
    s_setprio 0
    s_sleep 2
    s_cmp_gt_u32 s36, 399992
    s_cbranch_scc1 CH_RR1
    s_add_u32 s50, s56, 1
    s_and_b32 s50, s50, 7
    s_add_u32 s34, s50, s52
    s_add_u32 s50, s50, 1
    s_lshl_b32 s35, s34, 10
    s_mov_b32 exec_lo, 0x01010101
    s_mov_b32 exec_hi, 0x01010101
    buffer_atomic_or v25, v21, s[40:43], s35 offen sc1
    buffer_atomic_or v25, v22, s[40:43], s35 offen sc1
    s_mov_b64 exec, -1
    s_waitcnt vmcnt(0)
    s_sleep 16
CH_RR1:
    s_add_u32 s50, s56, 1
    s_and_b32 s50, s50, 7
    s_add_u32 s34, s50, s52
    s_add_u32 s50, s50, 1
    s_lshl_b32 s35, s34, 10
    buffer_load_dwordx4 v[184:187], v21, s[40:43], s35 offen sc1
    buffer_load_dwordx4 v[188:191], v22, s[40:43], s35 offen sc1
    s_and_b32 s50, s50, 7
    s_add_u32 s34, s50, s52
    s_add_u32 s50, s50, 1
    s_lshl_b32 s35, s34, 10
    buffer_load_dwordx4 v[192:195], v21, s[40:43], s35 offen sc1
    buffer_load_dwordx4 v[196:199], v22, s[40:43], s35 offen sc1
    s_and_b32 s50, s50, 7
    s_add_u32 s34, s50, s52
    s_add_u32 s50, s50, 1
    s_lshl_b32 s35, s34, 10
    buffer_load_dwordx4 v[200:203], v21, s[40:43], s35 offen sc1
    buffer_load_dwordx4 v[204:207], v22, s[40:43], s35 offen sc1
    s_and_b32 s50, s50, 7
    s_add_u32 s34, s50, s52
    s_add_u32 s50, s50, 1
    s_lshl_b32 s35, s34, 10
    buffer_load_dwordx4 v[208:211], v21, s[40:43], s35 offen sc1
    buffer_load_dwordx4 v[212:215], v22, s[40:43], s35 offen sc1
    s_and_b32 s50, s50, 7
    s_add_u32 s34, s50, s52
    s_add_u32 s50, s50, 1
    s_lshl_b32 s35, s34, 10
    buffer_load_dwordx4 v[216:219], v21, s[40:43], s35 offen sc1
    buffer_load_dwordx4 v[220:223], v22, s[40:43], s35 offen sc1
    s_and_b32 s50, s50, 7
    s_add_u32 s34, s50, s52
    s_add_u32 s50, s50, 1
    s_lshl_b32 s35, s34, 10
    buffer_load_dwordx4 v[224:227], v21, s[40:43], s35 offen sc1
    buffer_load_dwordx4 v[228:231], v22, s[40:43], s35 offen sc1
    s_and_b32 s50, s50, 7
    s_add_u32 s34, s50, s52
    s_add_u32 s50, s50, 1
    s_lshl_b32 s35, s34, 10
    buffer_load_dwordx4 v[232:235], v21, s[40:43], s35 offen sc1
    buffer_load_dwordx4 v[236:239], v22, s[40:43], s35 offen sc1
    s_branch CH_O1
CH_R2:
    s_cmp_eq_u32 s36, 0
    s_cbranch_scc1 CH_G2
    s_sub_u32 s36, s36, 1
    s_setprio 0
    s_sleep 2
    s_cmp_gt_u32 s36, 399992
    s_cbranch_scc1 CH_RR2
    s_add_u32 s50, s56, 2
    s_and_b32 s50, s50, 7
    s_add_u32 s34, s50, s52
    s_add_u32 s50, s50, 1
    s_lshl_b32 s35, s34, 10
    s_mov_b32 exec_lo, 0x01010101
    s_mov_b32 exec_hi, 0x01010101
    buffer_atomic_or v25, v21, s[40:43], s35 offen sc1
    buffer_atomic_or v25, v22, s[40:43], s35 offen sc1
    s_mov_b64 exec, -1
    s_waitcnt vmcnt(0)
    s_sleep 16
CH_RR2:
    s_add_u32 s50, s56, 2
    s_and_b32 s50, s50, 7
    s_add_u32 s34, s50, s52
    s_add_u32 s50, s50, 1
    s_lshl_b32 s35, s34, 10
    buffer_load_dwordx4 v[192:195], v21, s[40:43], s35 offen sc1
    buffer_load_dwordx4 v[196:199], v22, s[40:43], s35 offen sc1
    s_and_b32 s50, s50, 7
    s_add_u32 s34, s50, s52
    s_add_u32 s50, s50, 1
    s_lshl_b32 s35, s34, 10
    buffer_load_dwordx4 v[200:203], v21, s[40:43], s35 offen sc1
    buffer_load_dwordx4 v[204:207], v22, s[40:43], s35 offen sc1
    s_and_b32 s50, s50, 7
    s_add_u32 s34, s50, s52
    s_add_u32 s50, s50, 1
    s_lshl_b32 s35, s34, 10
    buffer_load_dwordx4 v[208:211], v21, s[40:43], s35 offen sc1
    buffer_load_dwordx4 v[212:215], v22, s[40:43], s35 offen sc1
    s_and_b32 s50, s50, 7
    s_add_u32 s34, s50, s52
    s_add_u32 s50, s50, 1
    s_lshl_b32 s35, s34, 10
    buffer_load_dwordx4 v[216:219], v21, s[40:43], s35 offen sc1
    buffer_load_dwordx4 v[220:223], v22, s[40:43], s35 offen sc1
    s_and_b32 s50, s50, 7
    s_add_u32 s34, s50, s52
    s_add_u32 s50, s50, 1
    s_lshl_b32 s35, s34, 10
    buffer_load_dwordx4 v[224:227], v21, s[40:43], s35 offen sc1
    buffer_load_dwordx4 v[228:231], v22, s[40:43], s35 offen sc1
    s_and_b32 s50, s50, 7
    s_add_u32 s34, s50, s52
    s_add_u32 s50, s50, 1
    s_lshl_b32 s35, s34, 10
    buffer_load_dwordx4 v[232:235], v21, s[40:43], s35 offen sc1
    buffer_load_dwordx4 v[236:239], v22, s[40:43], s35 offen sc1
    s_branch CH_O2
CH_R3:
    s_cmp_eq_u32 s36, 0
    s_cbranch_scc1 CH_G3
    s_sub_u32 s36, s36, 1
    s_setprio 0
    s_sleep 2
    s_cmp_gt_u32 s36, 399992
    s_cbranch_scc1 CH_RR3
    s_add_u32 s50, s56, 3
    s_and_b32 s50, s50, 7
    s_add_u32 s34, s50, s52
    s_add_u32 s50, s50, 1
    s_lshl_b32 s35, s34, 10
    s_mov_b32 exec_lo, 0x01010101
    s_mov_b32 exec_hi, 0x01010101
    buffer_atomic_or v25, v21, s[40:43], s35 offen sc1
    buffer_atomic_or v25, v22, s[40:43], s35 offen sc1
    s_mov_b64 exec, -1
    s_waitcnt vmcnt(0)
    s_sleep 16
CH_RR3:
    s_add_u32 s50, s56, 3
    s_and_b32 s50, s50, 7
    s_add_u32 s34, s50, s52
    s_add_u32 s50, s50, 1
    s_lshl_b32 s35, s34, 10
    buffer_load_dwordx4 v[200:203], v21, s[40:43], s35 offen sc1
    buffer_load_dwordx4 v[204:207], v22, s[40:43], s35 offen sc1
    s_and_b32 s50, s50, 7
    s_add_u32 s34, s50, s52
    s_add_u32 s50, s50, 1
    s_lshl_b32 s35, s34, 10
    buffer_load_dwordx4 v[208:211], v21, s[40:43], s35 offen sc1
    buffer_load_dwordx4 v[212:215], v22, s[40:43], s35 offen sc1
    s_and_b32 s50, s50, 7
    s_add_u32 s34, s50, s52
    s_add_u32 s50, s50, 1
    s_lshl_b32 s35, s34, 10
    buffer_load_dwordx4 v[216:219], v21, s[40:43], s35 offen sc1
    buffer_load_dwordx4 v[220:223], v22, s[40:43], s35 offen sc1
    s_and_b32 s50, s50, 7
    s_add_u32 s34, s50, s52
    s_add_u32 s50, s50, 1
    s_lshl_b32 s35, s34, 10
    buffer_load_dwordx4 v[224:227], v21, s[40:43], s35 offen sc1
    buffer_load_dwordx4 v[228:231], v22, s[40:43], s35 offen sc1
    s_and_b32 s50, s50, 7
    s_add_u32 s34, s50, s52
    s_add_u32 s50, s50, 1
    s_lshl_b32 s35, s34, 10
    buffer_load_dwordx4 v[232:235], v21, s[40:43], s35 offen sc1
    buffer_load_dwordx4 v[236:239], v22, s[40:43], s35 offen sc1
    s_branch CH_O3
CH_R4:
    s_cmp_eq_u32 s36, 0
    s_cbranch_scc1 CH_G4
    s_sub_u32 s36, s36, 1
    s_setprio 0
    s_sleep 2
    s_cmp_gt_u32 s36, 399992
    s_cbranch_scc1 CH_RR4
    s_add_u32 s50, s56, 4
    s_and_b32 s50, s50, 7
    s_add_u32 s34, s50, s52
    s_add_u32 s50, s50, 1
    s_lshl_b32 s35, s34, 10
    s_mov_b32 exec_lo, 0x01010101
    s_mov_b32 exec_hi, 0x01010101
    buffer_atomic_or v25, v21, s[40:43], s35 offen sc1
    buffer_atomic_or v25, v22, s[40:43], s35 offen sc1
    s_mov_b64 exec, -1
    s_waitcnt vmcnt(0)
    s_sleep 16
CH_RR4:
    s_add_u32 s50, s56, 4
    s_and_b32 s50, s50, 7
    s_add_u32 s34, s50, s52
    s_add_u32 s50, s50, 1
    s_lshl_b32 s35, s34, 10
    buffer_load_dwordx4 v[208:211], v21, s[40:43], s35 offen sc1
    buffer_load_dwordx4 v[212:215], v22, s[40:43], s35 offen sc1
    s_and_b32 s50, s50, 7
    s_add_u32 s34, s50, s52
    s_add_u32 s50, s50, 1
    s_lshl_b32 s35, s34, 10
    buffer_load_dwordx4 v[216:219], v21, s[40:43], s35 offen sc1
    buffer_load_dwordx4 v[220:223], v22, s[40:43], s35 offen sc1
    s_and_b32 s50, s50, 7
    s_add_u32 s34, s50, s52
    s_add_u32 s50, s50, 1
    s_lshl_b32 s35, s34, 10
    buffer_load_dwordx4 v[224:227], v21, s[40:43], s35 offen sc1
    buffer_load_dwordx4 v[228:231], v22, s[40:43], s35 offen sc1
    s_and_b32 s50, s50, 7
    s_add_u32 s34, s50, s52
    s_add_u32 s50, s50, 1
    s_lshl_b32 s35, s34, 10
    buffer_load_dwordx4 v[232:235], v21, s[40:43], s35 offen sc1
    buffer_load_dwordx4 v[236:239], v22, s[40:43], s35 offen sc1
    s_branch CH_O4
CH_R5:
    s_cmp_eq_u32 s36, 0
    s_cbranch_scc1 CH_G5
    s_sub_u32 s36, s36, 1
    s_setprio 0
    s_sleep 2
    s_cmp_gt_u32 s36, 399992
    s_cbranch_scc1 CH_RR5
    s_add_u32 s50, s56, 5
    s_and_b32 s50, s50, 7
    s_add_u32 s34, s50, s52
    s_add_u32 s50, s50, 1
    s_lshl_b32 s35, s34, 10
    s_mov_b32 exec_lo, 0x01010101
    s_mov_b32 exec_hi, 0x01010101
    buffer_atomic_or v25, v21, s[40:43], s35 offen sc1
    buffer_atomic_or v25, v22, s[40:43], s35 offen sc1
    s_mov_b64 exec, -1
    s_waitcnt vmcnt(0)
    s_sleep 16
CH_RR5:
    s_add_u32 s50, s56, 5
    s_and_b32 s50, s50, 7
    s_add_u32 s34, s50, s52
    s_add_u32 s50, s50, 1
    s_lshl_b32 s35, s34, 10
    buffer_load_dwordx4 v[216:219], v21, s[40:43], s35 offen sc1
    buffer_load_dwordx4 v[220:223], v22, s[40:43], s35 offen sc1
    s_and_b32 s50, s50, 7
    s_add_u32 s34, s50, s52
    s_add_u32 s50, s50, 1
    s_lshl_b32 s35, s34, 10
    buffer_load_dwordx4 v[224:227], v21, s[40:43], s35 offen sc1
    buffer_load_dwordx4 v[228:231], v22, s[40:43], s35 offen sc1
    s_and_b32 s50, s50, 7
    s_add_u32 s34, s50, s52
    s_add_u32 s50, s50, 1
    s_lshl_b32 s35, s34, 10
    buffer_load_dwordx4 v[232:235], v21, s[40:43], s35 offen sc1
    buffer_load_dwordx4 v[236:239], v22, s[40:43], s35 offen sc1
    s_branch CH_O5
CH_R6:
    s_cmp_eq_u32 s36, 0
    s_cbranch_scc1 CH_G6
    s_sub_u32 s36, s36, 1
    s_setprio 0
    s_sleep 2
    s_cmp_gt_u32 s36, 399992
    s_cbranch_scc1 CH_RR6
    s_add_u32 s50, s56, 6
    s_and_b32 s50, s50, 7
    s_add_u32 s34, s50, s52
    s_add_u32 s50, s50, 1
    s_lshl_b32 s35, s34, 10
    s_mov_b32 exec_lo, 0x01010101
    s_mov_b32 exec_hi, 0x01010101
    buffer_atomic_or v25, v21, s[40:43], s35 offen sc1
    buffer_atomic_or v25, v22, s[40:43], s35 offen sc1
    s_mov_b64 exec, -1
    s_waitcnt vmcnt(0)
    s_sleep 16
CH_RR6:
    s_add_u32 s50, s56, 6
    s_and_b32 s50, s50, 7
    s_add_u32 s34, s50, s52
    s_add_u32 s50, s50, 1
    s_lshl_b32 s35, s34, 10
    buffer_load_dwordx4 v[224:227], v21, s[40:43], s35 offen sc1
    buffer_load_dwordx4 v[228:231], v22, s[40:43], s35 offen sc1
    s_and_b32 s50, s50, 7
    s_add_u32 s34, s50, s52
    s_add_u32 s50, s50, 1
    s_lshl_b32 s35, s34, 10
    buffer_load_dwordx4 v[232:235], v21, s[40:43], s35 offen sc1
    buffer_load_dwordx4 v[236:239], v22, s[40:43], s35 offen sc1
    s_branch CH_O6
CH_R7:
    s_cmp_eq_u32 s36, 0
    s_cbranch_scc1 CH_G7
    s_sub_u32 s36, s36, 1
    s_setprio 0
    s_sleep 2
    s_cmp_gt_u32 s36, 399992
    s_cbranch_scc1 CH_RR7
    s_add_u32 s50, s56, 7
    s_and_b32 s50, s50, 7
    s_add_u32 s34, s50, s52
    s_add_u32 s50, s50, 1
    s_lshl_b32 s35, s34, 10
    s_mov_b32 exec_lo, 0x01010101
    s_mov_b32 exec_hi, 0x01010101
    buffer_atomic_or v25, v21, s[40:43], s35 offen sc1
    buffer_atomic_or v25, v22, s[40:43], s35 offen sc1
    s_mov_b64 exec, -1
    s_waitcnt vmcnt(0)
    s_sleep 16
CH_RR7:
    s_add_u32 s50, s56, 7
    s_and_b32 s50, s50, 7
    s_add_u32 s34, s50, s52
    s_add_u32 s50, s50, 1
    s_lshl_b32 s35, s34, 10
    buffer_load_dwordx4 v[232:235], v21, s[40:43], s35 offen sc1
    buffer_load_dwordx4 v[236:239], v22, s[40:43], s35 offen sc1
    s_branch CH_O7
K1_END:
    s_endpgm
.section .rodata,"a"
.p2align 6
.amdhsa_kernel parallel_sum__mha_block__mixer_s_mlp__prompt_kernel
  .amdhsa_next_free_vgpr 256
  .amdhsa_next_free_sgpr 102
  .amdhsa_accum_offset 256
  .amdhsa_group_segment_fixed_size 0
  .amdhsa_kernarg_size 88
  .amdhsa_user_sgpr_count 2
  .amdhsa_user_sgpr_kernarg_segment_ptr 1
  .amdhsa_system_sgpr_workgroup_id_x 1
  .amdhsa_float_denorm_mode_32 3
.end_amdhsa_kernel
```
